```python
import torch

def _softmax(x, axis=-1):
    return torch.softmax(x, dim=axis)
def _gelu(x):
    return torch.nn.functional.gelu(x, approximate="tanh")
def _silu(x):
    return torch.nn.functional.silu(x)
def _sigmoid(x):
    return torch.sigmoid(x)
def _layernorm(x, axis=-1, eps=1e-5):
    m = x.mean(dim=axis, keepdim=True)
    v = x.var(dim=axis, keepdim=True, unbiased=False)
    return (x - m) / torch.sqrt(v + eps)
def _scatter_add(tgt, idx, src, axis=0):
    return tgt.clone().index_add_(axis, idx, src)
def _segment_sum(src, seg, n):
    out = torch.zeros((n,) + src.shape[1:], dtype=src.dtype)
    return out.index_add_(0, seg, src)
def _pad(x, pw):
    flat = tuple(v for pair in reversed(pw) for v in pair)
    return torch.nn.functional.pad(x, flat)

kernel_name = 'standalone__paged_block_table_kv_pagedattention__sampling'

def setup_inputs():

    _w = (lambda a: (lambda t: t.to(torch.bfloat16) if t.is_floating_point() else t)(torch.as_tensor(a)))
    B, Hq, Hkv, Sq, Skv, D = 32, 32, 8, 4, 2048, 128
    bs = 16
    nbps = max(1, Skv // bs)
    num_phys = B * nbps + 4
    bt = torch.randperm(num_phys)[: B * nbps].reshape(B, nbps).to(torch.int64)
    cl = (nbps * bs - (torch.arange(1, B + 1, dtype=torch.int64) * 2654435761) % max(1, nbps * bs // 2)).to(torch.int64)
    return {
        "q": _w((lambda *s: torch.randn(*s, dtype=torch.bfloat16) * 0.8)(B, Hq, Sq, D)),
        "k_cache": _w((lambda *s: torch.randn(*s, dtype=torch.bfloat16) * 0.8)(num_phys, bs, Hkv, D)),
        "v_cache": _w((lambda *s: torch.randn(*s, dtype=torch.bfloat16) * 0.05)(num_phys, bs, Hkv, D)),
        "block_table": _w(bt),
        "context_lens": _w(cl),
    }

def reference(q, k_cache, v_cache, block_table, context_lens):
    B, Hq, Sq, D = q.shape
    bs = k_cache.shape[1]
    Hkv = k_cache.shape[2]
    nbps = block_table.shape[1]
    Skv = nbps * bs
    bt = block_table.reshape(-1)
    k = (lambda x, *d: x.permute(*d))(k_cache[bt].reshape(B, Skv, Hkv, D), 0, 2, 1, 3)
    v = (lambda x, *d: x.permute(*d))(v_cache[bt].reshape(B, Skv, Hkv, D), 0, 2, 1, 3)
    g = Hq // Hkv
    qg = q.reshape(B, Hkv, g, Sq, D)
    scores = torch.einsum("bhgqd,bhkd->bhgqk", qg, k) * (D ** -0.5)
    pos = torch.arange(Skv)
    msk = pos[None, :] < context_lens[:, None]
    scores = torch.where(msk[:, None, None, None, :], scores, -1e9)
    p = _softmax(scores, axis=-1)
    out = torch.einsum("bhgqk,bhkd->bhgqd", p, v)
    return out.reshape(B, Hq, Sq, D)
```

```asm
; @launch grid=(256,1,1) block=(384,1,1) lds=132928
.amdgcn_target "amdgcn-amd-amdhsa--gfx950"
.text
.globl standalone__paged_block_table_kv_pagedattention__sampling_kernel
.p2align 8
.type standalone__paged_block_table_kv_pagedattention__sampling_kernel,@function
standalone__paged_block_table_kv_pagedattention__sampling_kernel:
    s_cmp_ge_u32 s2, 256
    s_cbranch_scc1 L_end
    s_load_dwordx8 s[4:11], s[0:1], 0
    s_load_dwordx8 s[72:79], s[0:1], 32
    v_lshrrev_b32 v1, 6, v0
    v_and_b32 v0, 63, v0
    v_lshrrev_b32 v2, 4, v0
    v_readfirstlane_b32 s16, v1
    v_and_b32 v3, 15, v0
    s_lshr_b32 s17, s2, 3
    s_and_b32 s18, s2, 7
    v_lshlrev_b32 v4, 2, v0
    v_add_u32 v5, 131072, v4
    s_cmp_lg_u32 s16, 0
    s_cbranch_scc1 L_notloader
    s_setprio 3
    v_mov_b32 v19, 0
    ds_write_b32 v5, v19
    v_and_b32 v23, 0x7c, v4
    v_subrev_u32 v33, 12, v4
    s_lshl_b32 s20, s17, 9
    s_movk_i32 s34, 0x4000
    s_mov_b32 s35, 0x20000
    s_movk_i32 s38, 0x80
    s_mov_b32 s39, 0x20000
    s_mov_b32 s14, 0
    v_max_i32 v33, 0, v33
    s_waitcnt lgkmcnt(0)
    s_mov_b32 s32, s10
    s_mov_b32 s33, s11
    s_mov_b32 s36, s72
    s_mov_b32 s37, s73
L_ljob:
    buffer_load_dword v16, v4, s[32:35], s20 offen
    buffer_load_dword v18, v23, s[36:39], 0 offen
    buffer_load_dword v17, v4, s[32:35], s20 offen offset:256
    buffer_load_dword v28, v33, s[32:35], s20 offen
    buffer_load_dword v29, v4, s[32:35], s20 offen offset:244
    s_mov_b32 s24, s6
    s_mov_b32 s25, s7
    s_mov_b32 s26, 134348800
    s_mov_b32 s27, 0x20000
    s_mov_b32 s28, s8
    s_mov_b32 s29, s9
    s_mov_b32 s30, 134348800
    s_mov_b32 s31, 0x20000
    s_mov_b32 m0, 0
    s_lshl_b32 s19, s18, 8
    v_lshlrev_b32 v6, 11, v2
    v_add_u32 v6, s19, v6
    v_xor_b32 v7, v3, v2
    v_lshl_add_u32 v8, v7, 4, v6
    v_lshlrev_b32 v7, 1, v2
    v_xor_b32 v7, v3, v7
    v_lshl_add_u32 v12, v7, 4, v6
    v_xor_b32 v9, 0x40, v8
    v_xor_b32 v13, 0x80, v12
    v_add_u32 v9, 0x1c00, v9
    v_add_u32 v13, 0x1c00, v13
    v_xor_b32 v10, 0x80, v8
    v_xor_b32 v14, 0x0, v12
    v_add_u32 v10, 0x3800, v10
    v_add_u32 v14, 0x3800, v14
    v_xor_b32 v11, 0xc0, v8
    v_xor_b32 v15, 0x80, v12
    v_add_u32 v11, 0x5400, v11
    v_add_u32 v15, 0x5400, v15
    v_and_b32 v22, 3, v0
    v_lshlrev_b32 v22, 8, v22
    v_add_u32 v22, 131328, v22
    v_mov_b32 v19, 1
    v_and_b32 v32, 0x3c, v4
    v_add_u32 v32, 132864, v32
    s_lshr_b32 s3, s6, 8
    s_add_u32 s3, s3, s18
    s_and_b32 s3, s3, 3
    s_cmp_eq_u32 s3, 1
    s_cselect_b32 s15, 1, 0
    s_waitcnt vmcnt(4)
    v_readlane_b32 s60, v16, 0
    v_readlane_b32 s61, v16, 1
    v_readlane_b32 s62, v16, 2
    s_lshl_b32 s21, s60, 15
    buffer_load_dwordx4 v8, s[24:27], s21 offen nt lds
    buffer_load_dwordx4 v9, s[24:27], s21 offen offset:1024 nt lds
    buffer_load_dwordx4 v10, s[24:27], s21 offen offset:2048 nt lds
    buffer_load_dwordx4 v11, s[24:27], s21 offen offset:3072 nt lds
    s_lshl_b32 s21, s61, 15
    s_movk_i32 m0, 8192
    s_nop 0
    buffer_load_dwordx4 v8, s[24:27], s21 offen nt lds
    buffer_load_dwordx4 v9, s[24:27], s21 offen offset:1024 nt lds
    buffer_load_dwordx4 v10, s[24:27], s21 offen offset:2048 nt lds
    buffer_load_dwordx4 v11, s[24:27], s21 offen offset:3072 nt lds
    s_lshl_b32 s21, s62, 15
    s_movk_i32 m0, 16384
    s_nop 0
    buffer_load_dwordx4 v8, s[24:27], s21 offen nt lds
    buffer_load_dwordx4 v9, s[24:27], s21 offen offset:1024 nt lds
    buffer_load_dwordx4 v10, s[24:27], s21 offen offset:2048 nt lds
    buffer_load_dwordx4 v11, s[24:27], s21 offen offset:3072 nt lds
    s_waitcnt vmcnt(12) lgkmcnt(0)
    s_barrier
    ds_read_b32 v21, v22
    v_lshlrev_b32 v16, 15, v16
    v_lshlrev_b32 v17, 15, v17
    v_lshlrev_b32 v28, 15, v28
    v_lshlrev_b32 v29, 15, v29
    s_mov_b32 s45, -1
    s_mov_b32 s46, -1
    v_mov_b32 v31, v16
    s_cmp_lg_u32 s14, 0
    s_cbranch_scc1 L_lj2
    v_add_u32 v18, -1, v18
    v_min_u32 v18, 0x7ff, v18
    v_lshrrev_b32 v24, 4, v18
    v_readlane_b32 s56, v18, s17
    v_mov_b32 v27, v24
    s_nop 0
    v_max_u32_dpp v24, v24, v24 row_shr:1 row_mask:0xf bank_mask:0xf bound_ctrl:0
    v_add_u32_dpp v27, v27, v27 row_shr:1 row_mask:0xf bank_mask:0xf bound_ctrl:0
    s_nop 0
    v_max_u32_dpp v24, v24, v24 row_shr:2 row_mask:0xf bank_mask:0xf bound_ctrl:0
    v_add_u32_dpp v27, v27, v27 row_shr:2 row_mask:0xf bank_mask:0xf bound_ctrl:0
    s_nop 0
    v_max_u32_dpp v24, v24, v24 row_shr:4 row_mask:0xf bank_mask:0xf bound_ctrl:0
    v_add_u32_dpp v27, v27, v27 row_shr:4 row_mask:0xf bank_mask:0xf bound_ctrl:0
    s_nop 0
    v_max_u32_dpp v24, v24, v24 row_shr:8 row_mask:0xf bank_mask:0xf bound_ctrl:0
    v_add_u32_dpp v27, v27, v27 row_shr:8 row_mask:0xf bank_mask:0xf bound_ctrl:0
    s_nop 0
    s_lshr_b32 s22, s56, 4
    s_add_u32 s22, s22, 1
    v_readlane_b32 s23, v24, 15
    v_readlane_b32 s40, v24, 31
    v_readlane_b32 s50, v27, 15
    v_readlane_b32 s51, v27, 31
    s_max_u32 s23, s23, s40
    s_add_u32 s23, s23, 1
    s_add_u32 s50, s50, s51
    s_add_u32 s50, s50, 32
    v_cvt_f32_u32 v24, s23
    v_cvt_f32_u32 v25, s50
    v_cvt_f32_u32 v26, s22
    v_rcp_f32 v24, v24
    v_rcp_f32 v25, v25
    v_mov_b32 v30, 0x3f9eb852
    v_mul_f32 v27, v26, v24
    v_mul_f32 v24, 0x42f00000, v24
    v_mul_f32 v25, 0x45280000, v25
    v_fmac_f32 v30, 0xbe75c28f, v27
    v_min_f32 v24, v24, v25
    v_rcp_f32 v30, v30
    v_mul_f32 v24, v24, v26
    s_bitcmp1_b32 s3, 0
    s_cselect_b32 s51, 0x3f79999a, 1.0
    s_cmp_eq_u32 s3, 1
    s_cselect_b32 s51, 0x3f7d70a4, s51
    v_mul_f32 v24, s51, v24
    v_fma_f32 v24, v24, v30, 0.5
    v_cvt_u32_f32 v24, v24
    s_cmp_lg_u32 s15, 0
    s_cselect_b32 s45, 5, -1
    v_readfirstlane_b32 s13, v24
    s_cselect_b32 s40, 88, 0
    s_max_u32 s40, s40, s13
L_lj2:
    s_mov_b32 s42, 3
    v_readlane_b32 s21, v16, 3
    v_readlane_b32 s58, v28, 3
    s_mov_b32 s48, 24576
    s_movk_i32 s59, 4096
L_setlen:
    s_lshr_b32 s55, s56, 4
    s_add_u32 s22, s55, 1
    s_max_u32 s41, s22, 3
    s_add_u32 s41, s41, s22
    v_mov_b32 v20, s41
L_nextevt:
    s_max_u32 s44, s22, s42
    s_cmp_ge_u32 s55, s42
    s_cselect_b32 s57, s55, -1
    s_min_u32 s44, s44, s57
    s_cmp_ge_u32 s45, s42
    s_cselect_b32 s57, s45, -1
    s_min_u32 s44, s44, s57
    s_cmp_ge_u32 s46, s42
    s_cselect_b32 s57, s46, -1
    s_min_u32 s44, s44, s57
    s_cmp_le_u32 s42, 64
    s_cselect_b32 s57, 64, -1
    s_min_u32 s44, s44, s57
    s_lshl_b32 s54, s42, 1
    s_cmp_gt_u32 s40, 72
    s_cbranch_scc1 L_disp1
    s_cmp_gt_u32 s40, 48
    s_cbranch_scc1 L_disp2
    s_cmp_gt_u32 s40, 36
    s_cbranch_scc1 L_disp3
    s_cmp_gt_u32 s40, 30
    s_cbranch_scc1 L_disp4
    s_cmp_gt_u32 s40, 27
    s_cbranch_scc1 L_disp5
    s_cmp_gt_u32 s40, 25
    s_cbranch_scc1 L_disp6
    s_cmp_gt_u32 s40, 24
    s_cbranch_scc1 L_disp7
    s_branch L_w24
L_disp7:
    s_branch L_w25
L_disp6:
    s_cmp_gt_u32 s40, 26
    s_cbranch_scc1 L_disp8
    s_branch L_w26
L_disp8:
    s_branch L_w27
L_disp5:
    s_cmp_gt_u32 s40, 29
    s_cbranch_scc1 L_disp9
    s_cmp_gt_u32 s40, 28
    s_cbranch_scc1 L_disp10
    s_branch L_w28
L_disp10:
    s_branch L_w29
L_disp9:
    s_branch L_w30
L_disp4:
    s_cmp_gt_u32 s40, 33
    s_cbranch_scc1 L_disp11
    s_cmp_gt_u32 s40, 32
    s_cbranch_scc1 L_disp12
    s_cmp_gt_u32 s40, 31
    s_cbranch_scc1 L_disp13
    s_branch L_w31
L_disp13:
    s_branch L_w32
L_disp12:
    s_branch L_w33
L_disp11:
    s_cmp_gt_u32 s40, 35
    s_cbranch_scc1 L_disp14
    s_cmp_gt_u32 s40, 34
    s_cbranch_scc1 L_disp15
    s_branch L_w34
L_disp15:
    s_branch L_w35
L_disp14:
    s_branch L_w36
L_disp3:
    s_cmp_gt_u32 s40, 42
    s_cbranch_scc1 L_disp16
    s_cmp_gt_u32 s40, 39
    s_cbranch_scc1 L_disp17
    s_cmp_gt_u32 s40, 38
    s_cbranch_scc1 L_disp18
    s_cmp_gt_u32 s40, 37
    s_cbranch_scc1 L_disp19
    s_branch L_w37
L_disp19:
    s_branch L_w38
L_disp18:
    s_branch L_w39
L_disp17:
    s_cmp_gt_u32 s40, 41
    s_cbranch_scc1 L_disp20
    s_cmp_gt_u32 s40, 40
    s_cbranch_scc1 L_disp21
    s_branch L_w40
L_disp21:
    s_branch L_w41
L_disp20:
    s_branch L_w42
L_disp16:
    s_cmp_gt_u32 s40, 45
    s_cbranch_scc1 L_disp22
    s_cmp_gt_u32 s40, 44
    s_cbranch_scc1 L_disp23
    s_cmp_gt_u32 s40, 43
    s_cbranch_scc1 L_disp24
    s_branch L_w43
L_disp24:
    s_branch L_w44
L_disp23:
    s_branch L_w45
L_disp22:
    s_cmp_gt_u32 s40, 47
    s_cbranch_scc1 L_disp25
    s_cmp_gt_u32 s40, 46
    s_cbranch_scc1 L_disp26
    s_branch L_w46
L_disp26:
    s_branch L_w47
L_disp25:
    s_branch L_w48
L_disp2:
    s_cmp_gt_u32 s40, 60
    s_cbranch_scc1 L_disp27
    s_cmp_gt_u32 s40, 54
    s_cbranch_scc1 L_disp28
    s_cmp_gt_u32 s40, 51
    s_cbranch_scc1 L_disp29
    s_cmp_gt_u32 s40, 50
    s_cbranch_scc1 L_disp30
    s_cmp_gt_u32 s40, 49
    s_cbranch_scc1 L_disp31
    s_branch L_w49
L_disp31:
    s_branch L_w50
L_disp30:
    s_branch L_w51
L_disp29:
    s_cmp_gt_u32 s40, 53
    s_cbranch_scc1 L_disp32
    s_cmp_gt_u32 s40, 52
    s_cbranch_scc1 L_disp33
    s_branch L_w52
L_disp33:
    s_branch L_w53
L_disp32:
    s_branch L_w54
L_disp28:
    s_cmp_gt_u32 s40, 57
    s_cbranch_scc1 L_disp34
    s_cmp_gt_u32 s40, 56
    s_cbranch_scc1 L_disp35
    s_cmp_gt_u32 s40, 55
    s_cbranch_scc1 L_disp36
    s_branch L_w55
L_disp36:
    s_branch L_w56
L_disp35:
    s_branch L_w57
L_disp34:
    s_cmp_gt_u32 s40, 59
    s_cbranch_scc1 L_disp37
    s_cmp_gt_u32 s40, 58
    s_cbranch_scc1 L_disp38
    s_branch L_w58
L_disp38:
    s_branch L_w59
L_disp37:
    s_branch L_w60
L_disp27:
    s_cmp_gt_u32 s40, 66
    s_cbranch_scc1 L_disp39
    s_cmp_gt_u32 s40, 63
    s_cbranch_scc1 L_disp40
    s_cmp_gt_u32 s40, 62
    s_cbranch_scc1 L_disp41
    s_cmp_gt_u32 s40, 61
    s_cbranch_scc1 L_disp42
    s_branch L_w61
L_disp42:
    s_branch L_w62
L_disp41:
    s_branch L_w63
L_disp40:
    s_cmp_gt_u32 s40, 65
    s_cbranch_scc1 L_disp43
    s_cmp_gt_u32 s40, 64
    s_cbranch_scc1 L_disp44
    s_branch L_w64
L_disp44:
    s_branch L_w65
L_disp43:
    s_branch L_w66
L_disp39:
    s_cmp_gt_u32 s40, 69
    s_cbranch_scc1 L_disp45
    s_cmp_gt_u32 s40, 68
    s_cbranch_scc1 L_disp46
    s_cmp_gt_u32 s40, 67
    s_cbranch_scc1 L_disp47
    s_branch L_w67
L_disp47:
    s_branch L_w68
L_disp46:
    s_branch L_w69
L_disp45:
    s_cmp_gt_u32 s40, 71
    s_cbranch_scc1 L_disp48
    s_cmp_gt_u32 s40, 70
    s_cbranch_scc1 L_disp49
    s_branch L_w70
L_disp49:
    s_branch L_w71
L_disp48:
    s_branch L_w72
L_disp1:
    s_cmp_gt_u32 s40, 96
    s_cbranch_scc1 L_disp50
    s_cmp_gt_u32 s40, 84
    s_cbranch_scc1 L_disp51
    s_cmp_gt_u32 s40, 78
    s_cbranch_scc1 L_disp52
    s_cmp_gt_u32 s40, 75
    s_cbranch_scc1 L_disp53
    s_cmp_gt_u32 s40, 74
    s_cbranch_scc1 L_disp54
    s_cmp_gt_u32 s40, 73
    s_cbranch_scc1 L_disp55
    s_branch L_w73
L_disp55:
    s_branch L_w74
L_disp54:
    s_branch L_w75
L_disp53:
    s_cmp_gt_u32 s40, 77
    s_cbranch_scc1 L_disp56
    s_cmp_gt_u32 s40, 76
    s_cbranch_scc1 L_disp57
    s_branch L_w76
L_disp57:
    s_branch L_w77
L_disp56:
    s_branch L_w78
L_disp52:
    s_cmp_gt_u32 s40, 81
    s_cbranch_scc1 L_disp58
    s_cmp_gt_u32 s40, 80
    s_cbranch_scc1 L_disp59
    s_cmp_gt_u32 s40, 79
    s_cbranch_scc1 L_disp60
    s_branch L_w79
L_disp60:
    s_branch L_w80
L_disp59:
    s_branch L_w81
L_disp58:
    s_cmp_gt_u32 s40, 83
    s_cbranch_scc1 L_disp61
    s_cmp_gt_u32 s40, 82
    s_cbranch_scc1 L_disp62
    s_branch L_w82
L_disp62:
    s_branch L_w83
L_disp61:
    s_branch L_w84
L_disp51:
    s_cmp_gt_u32 s40, 90
    s_cbranch_scc1 L_disp63
    s_cmp_gt_u32 s40, 87
    s_cbranch_scc1 L_disp64
    s_cmp_gt_u32 s40, 86
    s_cbranch_scc1 L_disp65
    s_cmp_gt_u32 s40, 85
    s_cbranch_scc1 L_disp66
    s_branch L_w85
L_disp66:
    s_branch L_w86
L_disp65:
    s_branch L_w87
L_disp64:
    s_cmp_gt_u32 s40, 89
    s_cbranch_scc1 L_disp67
    s_cmp_gt_u32 s40, 88
    s_cbranch_scc1 L_disp68
    s_branch L_w88
L_disp68:
    s_branch L_w89
L_disp67:
    s_branch L_w90
L_disp63:
    s_cmp_gt_u32 s40, 93
    s_cbranch_scc1 L_disp69
    s_cmp_gt_u32 s40, 92
    s_cbranch_scc1 L_disp70
    s_cmp_gt_u32 s40, 91
    s_cbranch_scc1 L_disp71
    s_branch L_w91
L_disp71:
    s_branch L_w92
L_disp70:
    s_branch L_w93
L_disp69:
    s_cmp_gt_u32 s40, 95
    s_cbranch_scc1 L_disp72
    s_cmp_gt_u32 s40, 94
    s_cbranch_scc1 L_disp73
    s_branch L_w94
L_disp73:
    s_branch L_w95
L_disp72:
    s_branch L_w96
L_disp50:
    s_cmp_gt_u32 s40, 108
    s_cbranch_scc1 L_disp74
    s_cmp_gt_u32 s40, 102
    s_cbranch_scc1 L_disp75
    s_cmp_gt_u32 s40, 99
    s_cbranch_scc1 L_disp76
    s_cmp_gt_u32 s40, 98
    s_cbranch_scc1 L_disp77
    s_cmp_gt_u32 s40, 97
    s_cbranch_scc1 L_disp78
    s_branch L_w97
L_disp78:
    s_branch L_w98
L_disp77:
    s_branch L_w99
L_disp76:
    s_cmp_gt_u32 s40, 101
    s_cbranch_scc1 L_disp79
    s_cmp_gt_u32 s40, 100
    s_cbranch_scc1 L_disp80
    s_branch L_w100
L_disp80:
    s_branch L_w101
L_disp79:
    s_branch L_w102
L_disp75:
    s_cmp_gt_u32 s40, 105
    s_cbranch_scc1 L_disp81
    s_cmp_gt_u32 s40, 104
    s_cbranch_scc1 L_disp82
    s_cmp_gt_u32 s40, 103
    s_cbranch_scc1 L_disp83
    s_branch L_w103
L_disp83:
    s_branch L_w104
L_disp82:
    s_branch L_w105
L_disp81:
    s_cmp_gt_u32 s40, 107
    s_cbranch_scc1 L_disp84
    s_cmp_gt_u32 s40, 106
    s_cbranch_scc1 L_disp85
    s_branch L_w106
L_disp85:
    s_branch L_w107
L_disp84:
    s_branch L_w108
L_disp74:
    s_cmp_gt_u32 s40, 114
    s_cbranch_scc1 L_disp86
    s_cmp_gt_u32 s40, 111
    s_cbranch_scc1 L_disp87
    s_cmp_gt_u32 s40, 110
    s_cbranch_scc1 L_disp88
    s_cmp_gt_u32 s40, 109
    s_cbranch_scc1 L_disp89
    s_branch L_w109
L_disp89:
    s_branch L_w110
L_disp88:
    s_branch L_w111
L_disp87:
    s_cmp_gt_u32 s40, 113
    s_cbranch_scc1 L_disp90
    s_cmp_gt_u32 s40, 112
    s_cbranch_scc1 L_disp91
    s_branch L_w112
L_disp91:
    s_branch L_w113
L_disp90:
    s_branch L_w114
L_disp86:
    s_cmp_gt_u32 s40, 117
    s_cbranch_scc1 L_disp92
    s_cmp_gt_u32 s40, 116
    s_cbranch_scc1 L_disp93
    s_cmp_gt_u32 s40, 115
    s_cbranch_scc1 L_disp94
    s_branch L_w115
L_disp94:
    s_branch L_w116
L_disp93:
    s_branch L_w117
L_disp92:
    s_cmp_gt_u32 s40, 119
    s_cbranch_scc1 L_disp95
    s_cmp_gt_u32 s40, 118
    s_cbranch_scc1 L_disp96
    s_branch L_w118
L_disp96:
    s_branch L_w119
L_disp95:
    s_branch L_w120
L_rare:
    s_cmp_ge_u32 s42, s22
    s_cbranch_scc1 L_tail
    s_cmp_eq_u32 s42, s45
    s_cbranch_scc1 L_ev_plan
    s_cmp_eq_u32 s42, s46
    s_cbranch_scc1 L_ev_dec
    s_cmp_eq_u32 s42, s55
    s_cbranch_scc1 L_ev_last
    v_mov_b32 v16, v17
    v_mov_b32 v28, v29
    s_max_u32 s44, s22, s42
    v_readlane_b32 s21, v16, 0
    v_readlane_b32 s58, v28, 0
    s_cmp_ge_u32 s55, s42
    s_cselect_b32 s57, s55, -1
    s_min_u32 s44, s44, s57
    s_cmp_ge_u32 s46, s42
    s_cselect_b32 s57, s46, -1
    s_min_u32 s44, s44, s57
    s_lshl_b32 s54, s42, 1
    s_branch L_redisp
L_ev_last:
    s_and_b32 s57, s56, 15
    v_mov_b32 v6, 0x7fff0000
    v_cmp_ge_i32 s[64:65], s57, v2
    s_sub_u32 s57, s57, 4
    v_cmp_ge_i32 s[66:67], s57, v2
    s_sub_u32 s57, s57, 4
    v_cmp_ge_i32 s[68:69], s57, v2
    s_sub_u32 s57, s57, 4
    v_cmp_ge_i32 s[70:71], s57, v2
    s_sub_u32 s57, s57, 4
    s_nop 0
    v_cndmask_b32 v8, v6, v8, s[64:65]
    v_cndmask_b32 v9, v6, v9, s[66:67]
    v_cndmask_b32 v10, v6, v10, s[68:69]
    v_cndmask_b32 v11, v6, v11, s[70:71]
    s_mov_b32 s55, 0
    s_branch L_nextevt
L_ev_dec:
    ds_read_b32 v6, v32
    s_waitcnt lgkmcnt(0)
    v_readlane_b32 s57, v6, 8
    v_mov_b32 v7, 132900
    s_cmp_lg_u32 s57, 0
    s_cselect_b32 s57, 1, 2
    v_mov_b32 v6, s57
    ds_write_b32 v7, v6
    s_mov_b32 s46, -1
    s_branch L_nextevt
L_ev_plan:
    ds_read_b32 v6, v32
    s_waitcnt lgkmcnt(0)
    v_readlane_b32 s57, v6, 2
    s_cmp_eq_u32 s57, 0
    s_cbranch_scc1 L_ev_plan
    s_cmp_eq_u32 s57, 0x102
    s_cbranch_scc1 L_ev_helper
    v_readlane_b32 s56, v6, 0
    s_mov_b32 s45, -1
    s_mov_b32 s40, s13
    s_lshr_b32 s46, s56, 4
    s_sub_u32 s46, s46, 4
    s_cmp_eq_u32 s57, 0x101
    s_cselect_b32 s46, s46, -1
    s_branch L_setlen
L_ev_helper:
    v_readlane_b32 s13, v6, 1
    s_mov_b32 s12, s56
    v_readlane_b32 s20, v6, 3
    v_readlane_b32 s56, v6, 4
    s_movk_i32 s40, 96
    s_mov_b32 s14, 1
    s_waitcnt vmcnt(0)
    s_branch L_lrestart
L_redisp:
    s_cmp_gt_u32 s40, 72
    s_cbranch_scc1 L_disp97
    s_cmp_gt_u32 s40, 48
    s_cbranch_scc1 L_disp98
    s_cmp_gt_u32 s40, 36
    s_cbranch_scc1 L_disp99
    s_cmp_gt_u32 s40, 30
    s_cbranch_scc1 L_disp100
    s_cmp_gt_u32 s40, 27
    s_cbranch_scc1 L_disp101
    s_cmp_gt_u32 s40, 25
    s_cbranch_scc1 L_disp102
    s_cmp_gt_u32 s40, 24
    s_cbranch_scc1 L_disp103
    s_branch L_w24
L_disp103:
    s_branch L_w25
L_disp102:
    s_cmp_gt_u32 s40, 26
    s_cbranch_scc1 L_disp104
    s_branch L_w26
L_disp104:
    s_branch L_w27
L_disp101:
    s_cmp_gt_u32 s40, 29
    s_cbranch_scc1 L_disp105
    s_cmp_gt_u32 s40, 28
    s_cbranch_scc1 L_disp106
    s_branch L_w28
L_disp106:
    s_branch L_w29
L_disp105:
    s_branch L_w30
L_disp100:
    s_cmp_gt_u32 s40, 33
    s_cbranch_scc1 L_disp107
    s_cmp_gt_u32 s40, 32
    s_cbranch_scc1 L_disp108
    s_cmp_gt_u32 s40, 31
    s_cbranch_scc1 L_disp109
    s_branch L_w31
L_disp109:
    s_branch L_w32
L_disp108:
    s_branch L_w33
L_disp107:
    s_cmp_gt_u32 s40, 35
    s_cbranch_scc1 L_disp110
    s_cmp_gt_u32 s40, 34
    s_cbranch_scc1 L_disp111
    s_branch L_w34
L_disp111:
    s_branch L_w35
L_disp110:
    s_branch L_w36
L_disp99:
    s_cmp_gt_u32 s40, 42
    s_cbranch_scc1 L_disp112
    s_cmp_gt_u32 s40, 39
    s_cbranch_scc1 L_disp113
    s_cmp_gt_u32 s40, 38
    s_cbranch_scc1 L_disp114
    s_cmp_gt_u32 s40, 37
    s_cbranch_scc1 L_disp115
    s_branch L_w37
L_disp115:
    s_branch L_w38
L_disp114:
    s_branch L_w39
L_disp113:
    s_cmp_gt_u32 s40, 41
    s_cbranch_scc1 L_disp116
    s_cmp_gt_u32 s40, 40
    s_cbranch_scc1 L_disp117
    s_branch L_w40
L_disp117:
    s_branch L_w41
L_disp116:
    s_branch L_w42
L_disp112:
    s_cmp_gt_u32 s40, 45
    s_cbranch_scc1 L_disp118
    s_cmp_gt_u32 s40, 44
    s_cbranch_scc1 L_disp119
    s_cmp_gt_u32 s40, 43
    s_cbranch_scc1 L_disp120
    s_branch L_w43
L_disp120:
    s_branch L_w44
L_disp119:
    s_branch L_w45
L_disp118:
    s_cmp_gt_u32 s40, 47
    s_cbranch_scc1 L_disp121
    s_cmp_gt_u32 s40, 46
    s_cbranch_scc1 L_disp122
    s_branch L_w46
L_disp122:
    s_branch L_w47
L_disp121:
    s_branch L_w48
L_disp98:
    s_cmp_gt_u32 s40, 60
    s_cbranch_scc1 L_disp123
    s_cmp_gt_u32 s40, 54
    s_cbranch_scc1 L_disp124
    s_cmp_gt_u32 s40, 51
    s_cbranch_scc1 L_disp125
    s_cmp_gt_u32 s40, 50
    s_cbranch_scc1 L_disp126
    s_cmp_gt_u32 s40, 49
    s_cbranch_scc1 L_disp127
    s_branch L_w49
L_disp127:
    s_branch L_w50
L_disp126:
    s_branch L_w51
L_disp125:
    s_cmp_gt_u32 s40, 53
    s_cbranch_scc1 L_disp128
    s_cmp_gt_u32 s40, 52
    s_cbranch_scc1 L_disp129
    s_branch L_w52
L_disp129:
    s_branch L_w53
L_disp128:
    s_branch L_w54
L_disp124:
    s_cmp_gt_u32 s40, 57
    s_cbranch_scc1 L_disp130
    s_cmp_gt_u32 s40, 56
    s_cbranch_scc1 L_disp131
    s_cmp_gt_u32 s40, 55
    s_cbranch_scc1 L_disp132
    s_branch L_w55
L_disp132:
    s_branch L_w56
L_disp131:
    s_branch L_w57
L_disp130:
    s_cmp_gt_u32 s40, 59
    s_cbranch_scc1 L_disp133
    s_cmp_gt_u32 s40, 58
    s_cbranch_scc1 L_disp134
    s_branch L_w58
L_disp134:
    s_branch L_w59
L_disp133:
    s_branch L_w60
L_disp123:
    s_cmp_gt_u32 s40, 66
    s_cbranch_scc1 L_disp135
    s_cmp_gt_u32 s40, 63
    s_cbranch_scc1 L_disp136
    s_cmp_gt_u32 s40, 62
    s_cbranch_scc1 L_disp137
    s_cmp_gt_u32 s40, 61
    s_cbranch_scc1 L_disp138
    s_branch L_w61
L_disp138:
    s_branch L_w62
L_disp137:
    s_branch L_w63
L_disp136:
    s_cmp_gt_u32 s40, 65
    s_cbranch_scc1 L_disp139
    s_cmp_gt_u32 s40, 64
    s_cbranch_scc1 L_disp140
    s_branch L_w64
L_disp140:
    s_branch L_w65
L_disp139:
    s_branch L_w66
L_disp135:
    s_cmp_gt_u32 s40, 69
    s_cbranch_scc1 L_disp141
    s_cmp_gt_u32 s40, 68
    s_cbranch_scc1 L_disp142
    s_cmp_gt_u32 s40, 67
    s_cbranch_scc1 L_disp143
    s_branch L_w67
L_disp143:
    s_branch L_w68
L_disp142:
    s_branch L_w69
L_disp141:
    s_cmp_gt_u32 s40, 71
    s_cbranch_scc1 L_disp144
    s_cmp_gt_u32 s40, 70
    s_cbranch_scc1 L_disp145
    s_branch L_w70
L_disp145:
    s_branch L_w71
L_disp144:
    s_branch L_w72
L_disp97:
    s_cmp_gt_u32 s40, 96
    s_cbranch_scc1 L_disp146
    s_cmp_gt_u32 s40, 84
    s_cbranch_scc1 L_disp147
    s_cmp_gt_u32 s40, 78
    s_cbranch_scc1 L_disp148
    s_cmp_gt_u32 s40, 75
    s_cbranch_scc1 L_disp149
    s_cmp_gt_u32 s40, 74
    s_cbranch_scc1 L_disp150
    s_cmp_gt_u32 s40, 73
    s_cbranch_scc1 L_disp151
    s_branch L_w73
L_disp151:
    s_branch L_w74
L_disp150:
    s_branch L_w75
L_disp149:
    s_cmp_gt_u32 s40, 77
    s_cbranch_scc1 L_disp152
    s_cmp_gt_u32 s40, 76
    s_cbranch_scc1 L_disp153
    s_branch L_w76
L_disp153:
    s_branch L_w77
L_disp152:
    s_branch L_w78
L_disp148:
    s_cmp_gt_u32 s40, 81
    s_cbranch_scc1 L_disp154
    s_cmp_gt_u32 s40, 80
    s_cbranch_scc1 L_disp155
    s_cmp_gt_u32 s40, 79
    s_cbranch_scc1 L_disp156
    s_branch L_w79
L_disp156:
    s_branch L_w80
L_disp155:
    s_branch L_w81
L_disp154:
    s_cmp_gt_u32 s40, 83
    s_cbranch_scc1 L_disp157
    s_cmp_gt_u32 s40, 82
    s_cbranch_scc1 L_disp158
    s_branch L_w82
L_disp158:
    s_branch L_w83
L_disp157:
    s_branch L_w84
L_disp147:
    s_cmp_gt_u32 s40, 90
    s_cbranch_scc1 L_disp159
    s_cmp_gt_u32 s40, 87
    s_cbranch_scc1 L_disp160
    s_cmp_gt_u32 s40, 86
    s_cbranch_scc1 L_disp161
    s_cmp_gt_u32 s40, 85
    s_cbranch_scc1 L_disp162
    s_branch L_w85
L_disp162:
    s_branch L_w86
L_disp161:
    s_branch L_w87
L_disp160:
    s_cmp_gt_u32 s40, 89
    s_cbranch_scc1 L_disp163
    s_cmp_gt_u32 s40, 88
    s_cbranch_scc1 L_disp164
    s_branch L_w88
L_disp164:
    s_branch L_w89
L_disp163:
    s_branch L_w90
L_disp159:
    s_cmp_gt_u32 s40, 93
    s_cbranch_scc1 L_disp165
    s_cmp_gt_u32 s40, 92
    s_cbranch_scc1 L_disp166
    s_cmp_gt_u32 s40, 91
    s_cbranch_scc1 L_disp167
    s_branch L_w91
L_disp167:
    s_branch L_w92
L_disp166:
    s_branch L_w93
L_disp165:
    s_cmp_gt_u32 s40, 95
    s_cbranch_scc1 L_disp168
    s_cmp_gt_u32 s40, 94
    s_cbranch_scc1 L_disp169
    s_branch L_w94
L_disp169:
    s_branch L_w95
L_disp168:
    s_branch L_w96
L_disp146:
    s_cmp_gt_u32 s40, 108
    s_cbranch_scc1 L_disp170
    s_cmp_gt_u32 s40, 102
    s_cbranch_scc1 L_disp171
    s_cmp_gt_u32 s40, 99
    s_cbranch_scc1 L_disp172
    s_cmp_gt_u32 s40, 98
    s_cbranch_scc1 L_disp173
    s_cmp_gt_u32 s40, 97
    s_cbranch_scc1 L_disp174
    s_branch L_w97
L_disp174:
    s_branch L_w98
L_disp173:
    s_branch L_w99
L_disp172:
    s_cmp_gt_u32 s40, 101
    s_cbranch_scc1 L_disp175
    s_cmp_gt_u32 s40, 100
    s_cbranch_scc1 L_disp176
    s_branch L_w100
L_disp176:
    s_branch L_w101
L_disp175:
    s_branch L_w102
L_disp171:
    s_cmp_gt_u32 s40, 105
    s_cbranch_scc1 L_disp177
    s_cmp_gt_u32 s40, 104
    s_cbranch_scc1 L_disp178
    s_cmp_gt_u32 s40, 103
    s_cbranch_scc1 L_disp179
    s_branch L_w103
L_disp179:
    s_branch L_w104
L_disp178:
    s_branch L_w105
L_disp177:
    s_cmp_gt_u32 s40, 107
    s_cbranch_scc1 L_disp180
    s_cmp_gt_u32 s40, 106
    s_cbranch_scc1 L_disp181
    s_branch L_w106
L_disp181:
    s_branch L_w107
L_disp180:
    s_branch L_w108
L_disp170:
    s_cmp_gt_u32 s40, 114
    s_cbranch_scc1 L_disp182
    s_cmp_gt_u32 s40, 111
    s_cbranch_scc1 L_disp183
    s_cmp_gt_u32 s40, 110
    s_cbranch_scc1 L_disp184
    s_cmp_gt_u32 s40, 109
    s_cbranch_scc1 L_disp185
    s_branch L_w109
L_disp185:
    s_branch L_w110
L_disp184:
    s_branch L_w111
L_disp183:
    s_cmp_gt_u32 s40, 113
    s_cbranch_scc1 L_disp186
    s_cmp_gt_u32 s40, 112
    s_cbranch_scc1 L_disp187
    s_branch L_w112
L_disp187:
    s_branch L_w113
L_disp186:
    s_branch L_w114
L_disp182:
    s_cmp_gt_u32 s40, 117
    s_cbranch_scc1 L_disp188
    s_cmp_gt_u32 s40, 116
    s_cbranch_scc1 L_disp189
    s_cmp_gt_u32 s40, 115
    s_cbranch_scc1 L_disp190
    s_branch L_w115
L_disp190:
    s_branch L_w116
L_disp189:
    s_branch L_w117
L_disp188:
    s_cmp_gt_u32 s40, 119
    s_cbranch_scc1 L_disp191
    s_cmp_gt_u32 s40, 118
    s_cbranch_scc1 L_disp192
    s_branch L_w118
L_disp192:
    s_branch L_w119
L_disp191:
    s_branch L_w120
L_w24:
    v_mov_b32 v6, s54
    v_add_u32 v6, -5, v6
    s_waitcnt vmcnt(8)
    ds_write_b32 v5, v6
    s_branch L_w24_evt
L_w24_top:
    s_cmp_ge_u32 s42, s43
    s_cbranch_scc1 L_w24_evt
L_w24_go:
    s_and_b32 m0, s48, 0x1ffff
    s_waitcnt vmcnt(5)
    buffer_load_dwordx4 v8, s[24:27], s21 offen nt lds
    s_add_u32 s42, s42, 1
    s_waitcnt vmcnt(5)
    ds_add_u32 v5, v19
    buffer_load_dwordx4 v9, s[24:27], s21 offen offset:1024 nt lds
    s_add_u32 s48, s48, 0x2000
    s_waitcnt vmcnt(5)
    buffer_load_dwordx4 v10, s[24:27], s21 offen offset:2048 nt lds
    ds_read_b32 v21, v22
    s_waitcnt vmcnt(5)
    buffer_load_dwordx4 v11, s[24:27], s21 offen offset:3072 nt lds
    s_and_b32 m0, s59, 0x1ffff
    s_waitcnt vmcnt(5)
    buffer_load_dwordx4 v12, s[28:31], s58 offen nt lds
    v_readlane_b32 s21, v16, s42
    s_waitcnt vmcnt(5)
    ds_add_u32 v5, v19
    buffer_load_dwordx4 v13, s[28:31], s58 offen offset:1024 nt lds
    s_add_u32 s59, s59, 0x2000
    s_waitcnt vmcnt(5)
    buffer_load_dwordx4 v14, s[28:31], s58 offen offset:2048 nt lds
    s_waitcnt vmcnt(5)
    buffer_load_dwordx4 v15, s[28:31], s58 offen offset:3072 nt lds
    v_readlane_b32 s58, v28, s42
    s_branch L_w24_top
L_w24_evt:
    s_cmp_eq_u32 s42, s44
    s_cbranch_scc1 L_rare
L_w24_slow:
    s_waitcnt lgkmcnt(0)
    v_readlane_b32 s60, v21, 0
    v_readlane_b32 s61, v21, 1
    v_readlane_b32 s62, v21, 2
    v_readlane_b32 s63, v21, 3
    ds_read_b32 v21, v22
    s_min_u32 s60, s60, s61
    s_min_u32 s62, s62, s63
    s_min_u32 s47, s60, s62
    s_add_u32 s47, s47, 16
    s_min_u32 s43, s44, s47
    s_cmp_lt_u32 s42, s47
    s_cbranch_scc1 L_w24_go
    s_branch L_w24_slow
L_w25:
    v_mov_b32 v6, s54
    v_add_u32 v6, -5, v6
    s_waitcnt vmcnt(8)
    ds_write_b32 v5, v6
    s_branch L_w25_evt
L_w25_top:
    s_cmp_ge_u32 s42, s43
    s_cbranch_scc1 L_w25_evt
L_w25_go:
    s_and_b32 m0, s48, 0x1ffff
    s_waitcnt vmcnt(5)
    buffer_load_dwordx4 v8, s[24:27], s21 offen nt lds
    s_add_u32 s42, s42, 1
    s_waitcnt vmcnt(5)
    ds_add_u32 v5, v19
    buffer_load_dwordx4 v9, s[24:27], s21 offen offset:1024 nt lds
    s_add_u32 s48, s48, 0x2000
    s_waitcnt vmcnt(5)
    buffer_load_dwordx4 v10, s[24:27], s21 offen offset:2048 nt lds
    ds_read_b32 v21, v22
    s_waitcnt vmcnt(6)
    buffer_load_dwordx4 v11, s[24:27], s21 offen offset:3072 nt lds
    s_and_b32 m0, s59, 0x1ffff
    s_waitcnt vmcnt(5)
    buffer_load_dwordx4 v12, s[28:31], s58 offen nt lds
    v_readlane_b32 s21, v16, s42
    s_waitcnt vmcnt(5)
    ds_add_u32 v5, v19
    buffer_load_dwordx4 v13, s[28:31], s58 offen offset:1024 nt lds
    s_add_u32 s59, s59, 0x2000
    s_waitcnt vmcnt(5)
    buffer_load_dwordx4 v14, s[28:31], s58 offen offset:2048 nt lds
    s_waitcnt vmcnt(6)
    buffer_load_dwordx4 v15, s[28:31], s58 offen offset:3072 nt lds
    v_readlane_b32 s58, v28, s42
    s_branch L_w25_top
L_w25_evt:
    s_cmp_eq_u32 s42, s44
    s_cbranch_scc1 L_rare
L_w25_slow:
    s_waitcnt lgkmcnt(0)
    v_readlane_b32 s60, v21, 0
    v_readlane_b32 s61, v21, 1
    v_readlane_b32 s62, v21, 2
    v_readlane_b32 s63, v21, 3
    ds_read_b32 v21, v22
    s_min_u32 s60, s60, s61
    s_min_u32 s62, s62, s63
    s_min_u32 s47, s60, s62
    s_add_u32 s47, s47, 16
    s_min_u32 s43, s44, s47
    s_cmp_lt_u32 s42, s47
    s_cbranch_scc1 L_w25_go
    s_branch L_w25_slow
L_w26:
    v_mov_b32 v6, s54
    v_add_u32 v6, -5, v6
    s_waitcnt vmcnt(8)
    ds_write_b32 v5, v6
    s_branch L_w26_evt
L_w26_top:
    s_cmp_ge_u32 s42, s43
    s_cbranch_scc1 L_w26_evt
L_w26_go:
    s_and_b32 m0, s48, 0x1ffff
    s_waitcnt vmcnt(5)
    buffer_load_dwordx4 v8, s[24:27], s21 offen nt lds
    s_add_u32 s42, s42, 1
    s_waitcnt vmcnt(6)
    buffer_load_dwordx4 v9, s[24:27], s21 offen offset:1024 nt lds
    s_add_u32 s48, s48, 0x2000
    s_waitcnt vmcnt(5)
    ds_add_u32 v5, v19
    buffer_load_dwordx4 v10, s[24:27], s21 offen offset:2048 nt lds
    ds_read_b32 v21, v22
    s_waitcnt vmcnt(6)
    buffer_load_dwordx4 v11, s[24:27], s21 offen offset:3072 nt lds
    s_and_b32 m0, s59, 0x1ffff
    s_waitcnt vmcnt(5)
    buffer_load_dwordx4 v12, s[28:31], s58 offen nt lds
    v_readlane_b32 s21, v16, s42
    s_waitcnt vmcnt(6)
    buffer_load_dwordx4 v13, s[28:31], s58 offen offset:1024 nt lds
    s_add_u32 s59, s59, 0x2000
    s_waitcnt vmcnt(5)
    ds_add_u32 v5, v19
    buffer_load_dwordx4 v14, s[28:31], s58 offen offset:2048 nt lds
    s_waitcnt vmcnt(6)
    buffer_load_dwordx4 v15, s[28:31], s58 offen offset:3072 nt lds
    v_readlane_b32 s58, v28, s42
    s_branch L_w26_top
L_w26_evt:
    s_cmp_eq_u32 s42, s44
    s_cbranch_scc1 L_rare
L_w26_slow:
    s_waitcnt lgkmcnt(0)
    v_readlane_b32 s60, v21, 0
    v_readlane_b32 s61, v21, 1
    v_readlane_b32 s62, v21, 2
    v_readlane_b32 s63, v21, 3
    ds_read_b32 v21, v22
    s_min_u32 s60, s60, s61
    s_min_u32 s62, s62, s63
    s_min_u32 s47, s60, s62
    s_add_u32 s47, s47, 16
    s_min_u32 s43, s44, s47
    s_cmp_lt_u32 s42, s47
    s_cbranch_scc1 L_w26_go
    s_branch L_w26_slow
L_w27:
    v_mov_b32 v6, s54
    v_add_u32 v6, -5, v6
    s_waitcnt vmcnt(8)
    ds_write_b32 v5, v6
    s_branch L_w27_evt
L_w27_top:
    s_cmp_ge_u32 s42, s43
    s_cbranch_scc1 L_w27_evt
L_w27_go:
    s_and_b32 m0, s48, 0x1ffff
    s_waitcnt vmcnt(5)
    buffer_load_dwordx4 v8, s[24:27], s21 offen nt lds
    s_add_u32 s42, s42, 1
    s_waitcnt vmcnt(6)
    buffer_load_dwordx4 v9, s[24:27], s21 offen offset:1024 nt lds
    s_add_u32 s48, s48, 0x2000
    s_waitcnt vmcnt(6)
    ds_add_u32 v5, v19
    buffer_load_dwordx4 v10, s[24:27], s21 offen offset:2048 nt lds
    ds_read_b32 v21, v22
    s_waitcnt vmcnt(6)
    buffer_load_dwordx4 v11, s[24:27], s21 offen offset:3072 nt lds
    s_and_b32 m0, s59, 0x1ffff
    s_waitcnt vmcnt(5)
    buffer_load_dwordx4 v12, s[28:31], s58 offen nt lds
    v_readlane_b32 s21, v16, s42
    s_waitcnt vmcnt(6)
    buffer_load_dwordx4 v13, s[28:31], s58 offen offset:1024 nt lds
    s_add_u32 s59, s59, 0x2000
    s_waitcnt vmcnt(6)
    ds_add_u32 v5, v19
    buffer_load_dwordx4 v14, s[28:31], s58 offen offset:2048 nt lds
    s_waitcnt vmcnt(6)
    buffer_load_dwordx4 v15, s[28:31], s58 offen offset:3072 nt lds
    v_readlane_b32 s58, v28, s42
    s_branch L_w27_top
L_w27_evt:
    s_cmp_eq_u32 s42, s44
    s_cbranch_scc1 L_rare
L_w27_slow:
    s_waitcnt lgkmcnt(0)
    v_readlane_b32 s60, v21, 0
    v_readlane_b32 s61, v21, 1
    v_readlane_b32 s62, v21, 2
    v_readlane_b32 s63, v21, 3
    ds_read_b32 v21, v22
    s_min_u32 s60, s60, s61
    s_min_u32 s62, s62, s63
    s_min_u32 s47, s60, s62
    s_add_u32 s47, s47, 16
    s_min_u32 s43, s44, s47
    s_cmp_lt_u32 s42, s47
    s_cbranch_scc1 L_w27_go
    s_branch L_w27_slow
L_w28:
    v_mov_b32 v6, s54
    v_add_u32 v6, -5, v6
    s_waitcnt vmcnt(8)
    ds_write_b32 v5, v6
    s_branch L_w28_evt
L_w28_top:
    s_cmp_ge_u32 s42, s43
    s_cbranch_scc1 L_w28_evt
L_w28_go:
    s_and_b32 m0, s48, 0x1ffff
    s_waitcnt vmcnt(6)
    buffer_load_dwordx4 v8, s[24:27], s21 offen nt lds
    s_add_u32 s42, s42, 1
    s_waitcnt vmcnt(6)
    buffer_load_dwordx4 v9, s[24:27], s21 offen offset:1024 nt lds
    s_add_u32 s48, s48, 0x2000
    s_waitcnt vmcnt(6)
    ds_add_u32 v5, v19
    buffer_load_dwordx4 v10, s[24:27], s21 offen offset:2048 nt lds
    ds_read_b32 v21, v22
    s_waitcnt vmcnt(6)
    buffer_load_dwordx4 v11, s[24:27], s21 offen offset:3072 nt lds
    s_and_b32 m0, s59, 0x1ffff
    s_waitcnt vmcnt(6)
    buffer_load_dwordx4 v12, s[28:31], s58 offen nt lds
    v_readlane_b32 s21, v16, s42
    s_waitcnt vmcnt(6)
    buffer_load_dwordx4 v13, s[28:31], s58 offen offset:1024 nt lds
    s_add_u32 s59, s59, 0x2000
    s_waitcnt vmcnt(6)
    ds_add_u32 v5, v19
    buffer_load_dwordx4 v14, s[28:31], s58 offen offset:2048 nt lds
    s_waitcnt vmcnt(6)
    buffer_load_dwordx4 v15, s[28:31], s58 offen offset:3072 nt lds
    v_readlane_b32 s58, v28, s42
    s_branch L_w28_top
L_w28_evt:
    s_cmp_eq_u32 s42, s44
    s_cbranch_scc1 L_rare
L_w28_slow:
    s_waitcnt lgkmcnt(0)
    v_readlane_b32 s60, v21, 0
    v_readlane_b32 s61, v21, 1
    v_readlane_b32 s62, v21, 2
    v_readlane_b32 s63, v21, 3
    ds_read_b32 v21, v22
    s_min_u32 s60, s60, s61
    s_min_u32 s62, s62, s63
    s_min_u32 s47, s60, s62
    s_add_u32 s47, s47, 16
    s_min_u32 s43, s44, s47
    s_cmp_lt_u32 s42, s47
    s_cbranch_scc1 L_w28_go
    s_branch L_w28_slow
L_w29:
    v_mov_b32 v6, s54
    v_add_u32 v6, -5, v6
    s_waitcnt vmcnt(8)
    ds_write_b32 v5, v6
    s_branch L_w29_evt
L_w29_top:
    s_cmp_ge_u32 s42, s43
    s_cbranch_scc1 L_w29_evt
L_w29_go:
    s_and_b32 m0, s48, 0x1ffff
    s_waitcnt vmcnt(6)
    buffer_load_dwordx4 v8, s[24:27], s21 offen nt lds
    s_add_u32 s42, s42, 1
    s_waitcnt vmcnt(6)
    buffer_load_dwordx4 v9, s[24:27], s21 offen offset:1024 nt lds
    s_add_u32 s48, s48, 0x2000
    s_waitcnt vmcnt(6)
    ds_add_u32 v5, v19
    buffer_load_dwordx4 v10, s[24:27], s21 offen offset:2048 nt lds
    ds_read_b32 v21, v22
    s_waitcnt vmcnt(7)
    buffer_load_dwordx4 v11, s[24:27], s21 offen offset:3072 nt lds
    s_and_b32 m0, s59, 0x1ffff
    s_waitcnt vmcnt(6)
    buffer_load_dwordx4 v12, s[28:31], s58 offen nt lds
    v_readlane_b32 s21, v16, s42
    s_waitcnt vmcnt(6)
    buffer_load_dwordx4 v13, s[28:31], s58 offen offset:1024 nt lds
    s_add_u32 s59, s59, 0x2000
    s_waitcnt vmcnt(6)
    ds_add_u32 v5, v19
    buffer_load_dwordx4 v14, s[28:31], s58 offen offset:2048 nt lds
    s_waitcnt vmcnt(7)
    buffer_load_dwordx4 v15, s[28:31], s58 offen offset:3072 nt lds
    v_readlane_b32 s58, v28, s42
    s_branch L_w29_top
L_w29_evt:
    s_cmp_eq_u32 s42, s44
    s_cbranch_scc1 L_rare
L_w29_slow:
    s_waitcnt lgkmcnt(0)
    v_readlane_b32 s60, v21, 0
    v_readlane_b32 s61, v21, 1
    v_readlane_b32 s62, v21, 2
    v_readlane_b32 s63, v21, 3
    ds_read_b32 v21, v22
    s_min_u32 s60, s60, s61
    s_min_u32 s62, s62, s63
    s_min_u32 s47, s60, s62
    s_add_u32 s47, s47, 16
    s_min_u32 s43, s44, s47
    s_cmp_lt_u32 s42, s47
    s_cbranch_scc1 L_w29_go
    s_branch L_w29_slow
L_w30:
    v_mov_b32 v6, s54
    v_add_u32 v6, -5, v6
    s_waitcnt vmcnt(8)
    ds_write_b32 v5, v6
    s_branch L_w30_evt
L_w30_top:
    s_cmp_ge_u32 s42, s43
    s_cbranch_scc1 L_w30_evt
L_w30_go:
    s_and_b32 m0, s48, 0x1ffff
    s_waitcnt vmcnt(6)
    buffer_load_dwordx4 v8, s[24:27], s21 offen nt lds
    s_add_u32 s42, s42, 1
    s_waitcnt vmcnt(7)
    buffer_load_dwordx4 v9, s[24:27], s21 offen offset:1024 nt lds
    s_add_u32 s48, s48, 0x2000
    s_waitcnt vmcnt(6)
    ds_add_u32 v5, v19
    buffer_load_dwordx4 v10, s[24:27], s21 offen offset:2048 nt lds
    ds_read_b32 v21, v22
    s_waitcnt vmcnt(7)
    buffer_load_dwordx4 v11, s[24:27], s21 offen offset:3072 nt lds
    s_and_b32 m0, s59, 0x1ffff
    s_waitcnt vmcnt(6)
    buffer_load_dwordx4 v12, s[28:31], s58 offen nt lds
    v_readlane_b32 s21, v16, s42
    s_waitcnt vmcnt(7)
    buffer_load_dwordx4 v13, s[28:31], s58 offen offset:1024 nt lds
    s_add_u32 s59, s59, 0x2000
    s_waitcnt vmcnt(6)
    ds_add_u32 v5, v19
    buffer_load_dwordx4 v14, s[28:31], s58 offen offset:2048 nt lds
    s_waitcnt vmcnt(7)
    buffer_load_dwordx4 v15, s[28:31], s58 offen offset:3072 nt lds
    v_readlane_b32 s58, v28, s42
    s_branch L_w30_top
L_w30_evt:
    s_cmp_eq_u32 s42, s44
    s_cbranch_scc1 L_rare
L_w30_slow:
    s_waitcnt lgkmcnt(0)
    v_readlane_b32 s60, v21, 0
    v_readlane_b32 s61, v21, 1
    v_readlane_b32 s62, v21, 2
    v_readlane_b32 s63, v21, 3
    ds_read_b32 v21, v22
    s_min_u32 s60, s60, s61
    s_min_u32 s62, s62, s63
    s_min_u32 s47, s60, s62
    s_add_u32 s47, s47, 16
    s_min_u32 s43, s44, s47
    s_cmp_lt_u32 s42, s47
    s_cbranch_scc1 L_w30_go
    s_branch L_w30_slow
L_w31:
    v_mov_b32 v6, s54
    v_add_u32 v6, -5, v6
    s_waitcnt vmcnt(8)
    ds_write_b32 v5, v6
    s_branch L_w31_evt
L_w31_top:
    s_cmp_ge_u32 s42, s43
    s_cbranch_scc1 L_w31_evt
L_w31_go:
    s_and_b32 m0, s48, 0x1ffff
    s_waitcnt vmcnt(6)
    buffer_load_dwordx4 v8, s[24:27], s21 offen nt lds
    s_add_u32 s42, s42, 1
    s_waitcnt vmcnt(7)
    buffer_load_dwordx4 v9, s[24:27], s21 offen offset:1024 nt lds
    s_add_u32 s48, s48, 0x2000
    s_waitcnt vmcnt(7)
    buffer_load_dwordx4 v10, s[24:27], s21 offen offset:2048 nt lds
    ds_read_b32 v21, v22
    s_waitcnt vmcnt(7)
    ds_add_u32 v5, v19
    buffer_load_dwordx4 v11, s[24:27], s21 offen offset:3072 nt lds
    s_and_b32 m0, s59, 0x1ffff
    s_waitcnt vmcnt(6)
    buffer_load_dwordx4 v12, s[28:31], s58 offen nt lds
    v_readlane_b32 s21, v16, s42
    s_waitcnt vmcnt(7)
    buffer_load_dwordx4 v13, s[28:31], s58 offen offset:1024 nt lds
    s_add_u32 s59, s59, 0x2000
    s_waitcnt vmcnt(7)
    buffer_load_dwordx4 v14, s[28:31], s58 offen offset:2048 nt lds
    s_waitcnt vmcnt(7)
    ds_add_u32 v5, v19
    buffer_load_dwordx4 v15, s[28:31], s58 offen offset:3072 nt lds
    v_readlane_b32 s58, v28, s42
    s_branch L_w31_top
L_w31_evt:
    s_cmp_eq_u32 s42, s44
    s_cbranch_scc1 L_rare
L_w31_slow:
    s_waitcnt lgkmcnt(0)
    v_readlane_b32 s60, v21, 0
    v_readlane_b32 s61, v21, 1
    v_readlane_b32 s62, v21, 2
    v_readlane_b32 s63, v21, 3
    ds_read_b32 v21, v22
    s_min_u32 s60, s60, s61
    s_min_u32 s62, s62, s63
    s_min_u32 s47, s60, s62
    s_add_u32 s47, s47, 16
    s_min_u32 s43, s44, s47
    s_cmp_lt_u32 s42, s47
    s_cbranch_scc1 L_w31_go
    s_branch L_w31_slow
L_w32:
    v_mov_b32 v6, s54
    v_add_u32 v6, -5, v6
    s_waitcnt vmcnt(8)
    ds_write_b32 v5, v6
    s_branch L_w32_evt
L_w32_top:
    s_cmp_ge_u32 s42, s43
    s_cbranch_scc1 L_w32_evt
L_w32_go:
    s_and_b32 m0, s48, 0x1ffff
    s_waitcnt vmcnt(7)
    buffer_load_dwordx4 v8, s[24:27], s21 offen nt lds
    s_add_u32 s42, s42, 1
    s_waitcnt vmcnt(7)
    buffer_load_dwordx4 v9, s[24:27], s21 offen offset:1024 nt lds
    s_add_u32 s48, s48, 0x2000
    s_waitcnt vmcnt(7)
    buffer_load_dwordx4 v10, s[24:27], s21 offen offset:2048 nt lds
    ds_read_b32 v21, v22
    s_waitcnt vmcnt(7)
    ds_add_u32 v5, v19
    buffer_load_dwordx4 v11, s[24:27], s21 offen offset:3072 nt lds
    s_and_b32 m0, s59, 0x1ffff
    s_waitcnt vmcnt(7)
    buffer_load_dwordx4 v12, s[28:31], s58 offen nt lds
    v_readlane_b32 s21, v16, s42
    s_waitcnt vmcnt(7)
    buffer_load_dwordx4 v13, s[28:31], s58 offen offset:1024 nt lds
    s_add_u32 s59, s59, 0x2000
    s_waitcnt vmcnt(7)
    buffer_load_dwordx4 v14, s[28:31], s58 offen offset:2048 nt lds
    s_waitcnt vmcnt(7)
    ds_add_u32 v5, v19
    buffer_load_dwordx4 v15, s[28:31], s58 offen offset:3072 nt lds
    v_readlane_b32 s58, v28, s42
    s_branch L_w32_top
L_w32_evt:
    s_cmp_eq_u32 s42, s44
    s_cbranch_scc1 L_rare
L_w32_slow:
    s_waitcnt lgkmcnt(0)
    v_readlane_b32 s60, v21, 0
    v_readlane_b32 s61, v21, 1
    v_readlane_b32 s62, v21, 2
    v_readlane_b32 s63, v21, 3
    ds_read_b32 v21, v22
    s_min_u32 s60, s60, s61
    s_min_u32 s62, s62, s63
    s_min_u32 s47, s60, s62
    s_add_u32 s47, s47, 16
    s_min_u32 s43, s44, s47
    s_cmp_lt_u32 s42, s47
    s_cbranch_scc1 L_w32_go
    s_branch L_w32_slow
L_w33:
    v_mov_b32 v6, s54
    v_add_u32 v6, -6, v6
    s_waitcnt vmcnt(12)
    ds_write_b32 v5, v6
    s_branch L_w33_evt
L_w33_top:
    s_cmp_ge_u32 s42, s43
    s_cbranch_scc1 L_w33_evt
L_w33_go:
    s_and_b32 m0, s48, 0x1ffff
    s_waitcnt vmcnt(7)
    ds_add_u32 v5, v19
    buffer_load_dwordx4 v8, s[24:27], s21 offen nt lds
    s_add_u32 s42, s42, 1
    s_waitcnt vmcnt(7)
    buffer_load_dwordx4 v9, s[24:27], s21 offen offset:1024 nt lds
    s_add_u32 s48, s48, 0x2000
    s_waitcnt vmcnt(7)
    buffer_load_dwordx4 v10, s[24:27], s21 offen offset:2048 nt lds
    ds_read_b32 v21, v22
    s_waitcnt vmcnt(8)
    buffer_load_dwordx4 v11, s[24:27], s21 offen offset:3072 nt lds
    s_and_b32 m0, s59, 0x1ffff
    s_waitcnt vmcnt(7)
    ds_add_u32 v5, v19
    buffer_load_dwordx4 v12, s[28:31], s58 offen nt lds
    v_readlane_b32 s21, v16, s42
    s_waitcnt vmcnt(7)
    buffer_load_dwordx4 v13, s[28:31], s58 offen offset:1024 nt lds
    s_add_u32 s59, s59, 0x2000
    s_waitcnt vmcnt(7)
    buffer_load_dwordx4 v14, s[28:31], s58 offen offset:2048 nt lds
    s_waitcnt vmcnt(8)
    buffer_load_dwordx4 v15, s[28:31], s58 offen offset:3072 nt lds
    v_readlane_b32 s58, v28, s42
    s_branch L_w33_top
L_w33_evt:
    s_cmp_eq_u32 s42, s44
    s_cbranch_scc1 L_rare
L_w33_slow:
    s_waitcnt lgkmcnt(0)
    v_readlane_b32 s60, v21, 0
    v_readlane_b32 s61, v21, 1
    v_readlane_b32 s62, v21, 2
    v_readlane_b32 s63, v21, 3
    ds_read_b32 v21, v22
    s_min_u32 s60, s60, s61
    s_min_u32 s62, s62, s63
    s_min_u32 s47, s60, s62
    s_add_u32 s47, s47, 16
    s_min_u32 s43, s44, s47
    s_cmp_lt_u32 s42, s47
    s_cbranch_scc1 L_w33_go
    s_branch L_w33_slow
L_w34:
    v_mov_b32 v6, s54
    v_add_u32 v6, -6, v6
    s_waitcnt vmcnt(12)
    ds_write_b32 v5, v6
    s_branch L_w34_evt
L_w34_top:
    s_cmp_ge_u32 s42, s43
    s_cbranch_scc1 L_w34_evt
L_w34_go:
    s_and_b32 m0, s48, 0x1ffff
    s_waitcnt vmcnt(7)
    ds_add_u32 v5, v19
    buffer_load_dwordx4 v8, s[24:27], s21 offen nt lds
    s_add_u32 s42, s42, 1
    s_waitcnt vmcnt(8)
    buffer_load_dwordx4 v9, s[24:27], s21 offen offset:1024 nt lds
    s_add_u32 s48, s48, 0x2000
    s_waitcnt vmcnt(7)
    buffer_load_dwordx4 v10, s[24:27], s21 offen offset:2048 nt lds
    ds_read_b32 v21, v22
    s_waitcnt vmcnt(8)
    buffer_load_dwordx4 v11, s[24:27], s21 offen offset:3072 nt lds
    s_and_b32 m0, s59, 0x1ffff
    s_waitcnt vmcnt(7)
    ds_add_u32 v5, v19
    buffer_load_dwordx4 v12, s[28:31], s58 offen nt lds
    v_readlane_b32 s21, v16, s42
    s_waitcnt vmcnt(8)
    buffer_load_dwordx4 v13, s[28:31], s58 offen offset:1024 nt lds
    s_add_u32 s59, s59, 0x2000
    s_waitcnt vmcnt(7)
    buffer_load_dwordx4 v14, s[28:31], s58 offen offset:2048 nt lds
    s_waitcnt vmcnt(8)
    buffer_load_dwordx4 v15, s[28:31], s58 offen offset:3072 nt lds
    v_readlane_b32 s58, v28, s42
    s_branch L_w34_top
L_w34_evt:
    s_cmp_eq_u32 s42, s44
    s_cbranch_scc1 L_rare
L_w34_slow:
    s_waitcnt lgkmcnt(0)
    v_readlane_b32 s60, v21, 0
    v_readlane_b32 s61, v21, 1
    v_readlane_b32 s62, v21, 2
    v_readlane_b32 s63, v21, 3
    ds_read_b32 v21, v22
    s_min_u32 s60, s60, s61
    s_min_u32 s62, s62, s63
    s_min_u32 s47, s60, s62
    s_add_u32 s47, s47, 16
    s_min_u32 s43, s44, s47
    s_cmp_lt_u32 s42, s47
    s_cbranch_scc1 L_w34_go
    s_branch L_w34_slow
L_w35:
    v_mov_b32 v6, s54
    v_add_u32 v6, -6, v6
    s_waitcnt vmcnt(12)
    ds_write_b32 v5, v6
    s_branch L_w35_evt
L_w35_top:
    s_cmp_ge_u32 s42, s43
    s_cbranch_scc1 L_w35_evt
L_w35_go:
    s_and_b32 m0, s48, 0x1ffff
    s_waitcnt vmcnt(7)
    ds_add_u32 v5, v19
    buffer_load_dwordx4 v8, s[24:27], s21 offen nt lds
    s_add_u32 s42, s42, 1
    s_waitcnt vmcnt(8)
    buffer_load_dwordx4 v9, s[24:27], s21 offen offset:1024 nt lds
    s_add_u32 s48, s48, 0x2000
    s_waitcnt vmcnt(8)
    buffer_load_dwordx4 v10, s[24:27], s21 offen offset:2048 nt lds
    ds_read_b32 v21, v22
    s_waitcnt vmcnt(8)
    buffer_load_dwordx4 v11, s[24:27], s21 offen offset:3072 nt lds
    s_and_b32 m0, s59, 0x1ffff
    s_waitcnt vmcnt(7)
    ds_add_u32 v5, v19
    buffer_load_dwordx4 v12, s[28:31], s58 offen nt lds
    v_readlane_b32 s21, v16, s42
    s_waitcnt vmcnt(8)
    buffer_load_dwordx4 v13, s[28:31], s58 offen offset:1024 nt lds
    s_add_u32 s59, s59, 0x2000
    s_waitcnt vmcnt(8)
    buffer_load_dwordx4 v14, s[28:31], s58 offen offset:2048 nt lds
    s_waitcnt vmcnt(8)
    buffer_load_dwordx4 v15, s[28:31], s58 offen offset:3072 nt lds
    v_readlane_b32 s58, v28, s42
    s_branch L_w35_top
L_w35_evt:
    s_cmp_eq_u32 s42, s44
    s_cbranch_scc1 L_rare
L_w35_slow:
    s_waitcnt lgkmcnt(0)
    v_readlane_b32 s60, v21, 0
    v_readlane_b32 s61, v21, 1
    v_readlane_b32 s62, v21, 2
    v_readlane_b32 s63, v21, 3
    ds_read_b32 v21, v22
    s_min_u32 s60, s60, s61
    s_min_u32 s62, s62, s63
    s_min_u32 s47, s60, s62
    s_add_u32 s47, s47, 16
    s_min_u32 s43, s44, s47
    s_cmp_lt_u32 s42, s47
    s_cbranch_scc1 L_w35_go
    s_branch L_w35_slow
L_w36:
    v_mov_b32 v6, s54
    v_add_u32 v6, -6, v6
    s_waitcnt vmcnt(12)
    ds_write_b32 v5, v6
    s_branch L_w36_evt
L_w36_top:
    s_cmp_ge_u32 s42, s43
    s_cbranch_scc1 L_w36_evt
L_w36_go:
    s_and_b32 m0, s48, 0x1ffff
    s_waitcnt vmcnt(8)
    ds_add_u32 v5, v19
    buffer_load_dwordx4 v8, s[24:27], s21 offen nt lds
    s_add_u32 s42, s42, 1
    s_waitcnt vmcnt(8)
    buffer_load_dwordx4 v9, s[24:27], s21 offen offset:1024 nt lds
    s_add_u32 s48, s48, 0x2000
    s_waitcnt vmcnt(8)
    buffer_load_dwordx4 v10, s[24:27], s21 offen offset:2048 nt lds
    ds_read_b32 v21, v22
    s_waitcnt vmcnt(8)
    buffer_load_dwordx4 v11, s[24:27], s21 offen offset:3072 nt lds
    s_and_b32 m0, s59, 0x1ffff
    s_waitcnt vmcnt(8)
    ds_add_u32 v5, v19
    buffer_load_dwordx4 v12, s[28:31], s58 offen nt lds
    v_readlane_b32 s21, v16, s42
    s_waitcnt vmcnt(8)
    buffer_load_dwordx4 v13, s[28:31], s58 offen offset:1024 nt lds
    s_add_u32 s59, s59, 0x2000
    s_waitcnt vmcnt(8)
    buffer_load_dwordx4 v14, s[28:31], s58 offen offset:2048 nt lds
    s_waitcnt vmcnt(8)
    buffer_load_dwordx4 v15, s[28:31], s58 offen offset:3072 nt lds
    v_readlane_b32 s58, v28, s42
    s_branch L_w36_top
L_w36_evt:
    s_cmp_eq_u32 s42, s44
    s_cbranch_scc1 L_rare
L_w36_slow:
    s_waitcnt lgkmcnt(0)
    v_readlane_b32 s60, v21, 0
    v_readlane_b32 s61, v21, 1
    v_readlane_b32 s62, v21, 2
    v_readlane_b32 s63, v21, 3
    ds_read_b32 v21, v22
    s_min_u32 s60, s60, s61
    s_min_u32 s62, s62, s63
    s_min_u32 s47, s60, s62
    s_add_u32 s47, s47, 16
    s_min_u32 s43, s44, s47
    s_cmp_lt_u32 s42, s47
    s_cbranch_scc1 L_w36_go
    s_branch L_w36_slow
L_w37:
    v_mov_b32 v6, s54
    v_add_u32 v6, -6, v6
    s_waitcnt vmcnt(12)
    ds_write_b32 v5, v6
    s_branch L_w37_evt
L_w37_top:
    s_cmp_ge_u32 s42, s43
    s_cbranch_scc1 L_w37_evt
L_w37_go:
    s_and_b32 m0, s48, 0x1ffff
    s_waitcnt vmcnt(8)
    ds_add_u32 v5, v19
    buffer_load_dwordx4 v8, s[24:27], s21 offen nt lds
    s_add_u32 s42, s42, 1
    s_waitcnt vmcnt(8)
    buffer_load_dwordx4 v9, s[24:27], s21 offen offset:1024 nt lds
    s_add_u32 s48, s48, 0x2000
    s_waitcnt vmcnt(8)
    buffer_load_dwordx4 v10, s[24:27], s21 offen offset:2048 nt lds
    ds_read_b32 v21, v22
    s_waitcnt vmcnt(9)
    buffer_load_dwordx4 v11, s[24:27], s21 offen offset:3072 nt lds
    s_and_b32 m0, s59, 0x1ffff
    s_waitcnt vmcnt(8)
    ds_add_u32 v5, v19
    buffer_load_dwordx4 v12, s[28:31], s58 offen nt lds
    v_readlane_b32 s21, v16, s42
    s_waitcnt vmcnt(8)
    buffer_load_dwordx4 v13, s[28:31], s58 offen offset:1024 nt lds
    s_add_u32 s59, s59, 0x2000
    s_waitcnt vmcnt(8)
    buffer_load_dwordx4 v14, s[28:31], s58 offen offset:2048 nt lds
    s_waitcnt vmcnt(9)
    buffer_load_dwordx4 v15, s[28:31], s58 offen offset:3072 nt lds
    v_readlane_b32 s58, v28, s42
    s_branch L_w37_top
L_w37_evt:
    s_cmp_eq_u32 s42, s44
    s_cbranch_scc1 L_rare
L_w37_slow:
    s_waitcnt lgkmcnt(0)
    v_readlane_b32 s60, v21, 0
    v_readlane_b32 s61, v21, 1
    v_readlane_b32 s62, v21, 2
    v_readlane_b32 s63, v21, 3
    ds_read_b32 v21, v22
    s_min_u32 s60, s60, s61
    s_min_u32 s62, s62, s63
    s_min_u32 s47, s60, s62
    s_add_u32 s47, s47, 16
    s_min_u32 s43, s44, s47
    s_cmp_lt_u32 s42, s47
    s_cbranch_scc1 L_w37_go
    s_branch L_w37_slow
L_w38:
    v_mov_b32 v6, s54
    v_add_u32 v6, -6, v6
    s_waitcnt vmcnt(12)
    ds_write_b32 v5, v6
    s_branch L_w38_evt
L_w38_top:
    s_cmp_ge_u32 s42, s43
    s_cbranch_scc1 L_w38_evt
L_w38_go:
    s_and_b32 m0, s48, 0x1ffff
    s_waitcnt vmcnt(8)
    ds_add_u32 v5, v19
    buffer_load_dwordx4 v8, s[24:27], s21 offen nt lds
    s_add_u32 s42, s42, 1
    s_waitcnt vmcnt(9)
    buffer_load_dwordx4 v9, s[24:27], s21 offen offset:1024 nt lds
    s_add_u32 s48, s48, 0x2000
    s_waitcnt vmcnt(8)
    buffer_load_dwordx4 v10, s[24:27], s21 offen offset:2048 nt lds
    ds_read_b32 v21, v22
    s_waitcnt vmcnt(9)
    buffer_load_dwordx4 v11, s[24:27], s21 offen offset:3072 nt lds
    s_and_b32 m0, s59, 0x1ffff
    s_waitcnt vmcnt(8)
    ds_add_u32 v5, v19
    buffer_load_dwordx4 v12, s[28:31], s58 offen nt lds
    v_readlane_b32 s21, v16, s42
    s_waitcnt vmcnt(9)
    buffer_load_dwordx4 v13, s[28:31], s58 offen offset:1024 nt lds
    s_add_u32 s59, s59, 0x2000
    s_waitcnt vmcnt(8)
    buffer_load_dwordx4 v14, s[28:31], s58 offen offset:2048 nt lds
    s_waitcnt vmcnt(9)
    buffer_load_dwordx4 v15, s[28:31], s58 offen offset:3072 nt lds
    v_readlane_b32 s58, v28, s42
    s_branch L_w38_top
L_w38_evt:
    s_cmp_eq_u32 s42, s44
    s_cbranch_scc1 L_rare
L_w38_slow:
    s_waitcnt lgkmcnt(0)
    v_readlane_b32 s60, v21, 0
    v_readlane_b32 s61, v21, 1
    v_readlane_b32 s62, v21, 2
    v_readlane_b32 s63, v21, 3
    ds_read_b32 v21, v22
    s_min_u32 s60, s60, s61
    s_min_u32 s62, s62, s63
    s_min_u32 s47, s60, s62
    s_add_u32 s47, s47, 16
    s_min_u32 s43, s44, s47
    s_cmp_lt_u32 s42, s47
    s_cbranch_scc1 L_w38_go
    s_branch L_w38_slow
L_w39:
    v_mov_b32 v6, s54
    v_add_u32 v6, -6, v6
    s_waitcnt vmcnt(12)
    ds_write_b32 v5, v6
    s_branch L_w39_evt
L_w39_top:
    s_cmp_ge_u32 s42, s43
    s_cbranch_scc1 L_w39_evt
L_w39_go:
    s_and_b32 m0, s48, 0x1ffff
    s_waitcnt vmcnt(8)
    ds_add_u32 v5, v19
    buffer_load_dwordx4 v8, s[24:27], s21 offen nt lds
    s_add_u32 s42, s42, 1
    s_waitcnt vmcnt(9)
    buffer_load_dwordx4 v9, s[24:27], s21 offen offset:1024 nt lds
    s_add_u32 s48, s48, 0x2000
    s_waitcnt vmcnt(9)
    buffer_load_dwordx4 v10, s[24:27], s21 offen offset:2048 nt lds
    ds_read_b32 v21, v22
    s_waitcnt vmcnt(9)
    buffer_load_dwordx4 v11, s[24:27], s21 offen offset:3072 nt lds
    s_and_b32 m0, s59, 0x1ffff
    s_waitcnt vmcnt(8)
    ds_add_u32 v5, v19
    buffer_load_dwordx4 v12, s[28:31], s58 offen nt lds
    v_readlane_b32 s21, v16, s42
    s_waitcnt vmcnt(9)
    buffer_load_dwordx4 v13, s[28:31], s58 offen offset:1024 nt lds
    s_add_u32 s59, s59, 0x2000
    s_waitcnt vmcnt(9)
    buffer_load_dwordx4 v14, s[28:31], s58 offen offset:2048 nt lds
    s_waitcnt vmcnt(9)
    buffer_load_dwordx4 v15, s[28:31], s58 offen offset:3072 nt lds
    v_readlane_b32 s58, v28, s42
    s_branch L_w39_top
L_w39_evt:
    s_cmp_eq_u32 s42, s44
    s_cbranch_scc1 L_rare
L_w39_slow:
    s_waitcnt lgkmcnt(0)
    v_readlane_b32 s60, v21, 0
    v_readlane_b32 s61, v21, 1
    v_readlane_b32 s62, v21, 2
    v_readlane_b32 s63, v21, 3
    ds_read_b32 v21, v22
    s_min_u32 s60, s60, s61
    s_min_u32 s62, s62, s63
    s_min_u32 s47, s60, s62
    s_add_u32 s47, s47, 16
    s_min_u32 s43, s44, s47
    s_cmp_lt_u32 s42, s47
    s_cbranch_scc1 L_w39_go
    s_branch L_w39_slow
L_w40:
    v_mov_b32 v6, s54
    v_add_u32 v6, -6, v6
    s_waitcnt vmcnt(12)
    ds_write_b32 v5, v6
    s_branch L_w40_evt
L_w40_top:
    s_cmp_ge_u32 s42, s43
    s_cbranch_scc1 L_w40_evt
L_w40_go:
    s_and_b32 m0, s48, 0x1ffff
    s_waitcnt vmcnt(9)
    buffer_load_dwordx4 v8, s[24:27], s21 offen nt lds
    s_add_u32 s42, s42, 1
    s_waitcnt vmcnt(9)
    ds_add_u32 v5, v19
    buffer_load_dwordx4 v9, s[24:27], s21 offen offset:1024 nt lds
    s_add_u32 s48, s48, 0x2000
    s_waitcnt vmcnt(9)
    buffer_load_dwordx4 v10, s[24:27], s21 offen offset:2048 nt lds
    ds_read_b32 v21, v22
    s_waitcnt vmcnt(9)
    buffer_load_dwordx4 v11, s[24:27], s21 offen offset:3072 nt lds
    s_and_b32 m0, s59, 0x1ffff
    s_waitcnt vmcnt(9)
    buffer_load_dwordx4 v12, s[28:31], s58 offen nt lds
    v_readlane_b32 s21, v16, s42
    s_waitcnt vmcnt(9)
    ds_add_u32 v5, v19
    buffer_load_dwordx4 v13, s[28:31], s58 offen offset:1024 nt lds
    s_add_u32 s59, s59, 0x2000
    s_waitcnt vmcnt(9)
    buffer_load_dwordx4 v14, s[28:31], s58 offen offset:2048 nt lds
    s_waitcnt vmcnt(9)
    buffer_load_dwordx4 v15, s[28:31], s58 offen offset:3072 nt lds
    v_readlane_b32 s58, v28, s42
    s_branch L_w40_top
L_w40_evt:
    s_cmp_eq_u32 s42, s44
    s_cbranch_scc1 L_rare
L_w40_slow:
    s_waitcnt lgkmcnt(0)
    v_readlane_b32 s60, v21, 0
    v_readlane_b32 s61, v21, 1
    v_readlane_b32 s62, v21, 2
    v_readlane_b32 s63, v21, 3
    ds_read_b32 v21, v22
    s_min_u32 s60, s60, s61
    s_min_u32 s62, s62, s63
    s_min_u32 s47, s60, s62
    s_add_u32 s47, s47, 16
    s_min_u32 s43, s44, s47
    s_cmp_lt_u32 s42, s47
    s_cbranch_scc1 L_w40_go
    s_branch L_w40_slow
L_w41:
    v_mov_b32 v6, s54
    v_add_u32 v6, -6, v6
    s_waitcnt vmcnt(12)
    ds_write_b32 v5, v6
    s_branch L_w41_evt
L_w41_top:
    s_cmp_ge_u32 s42, s43
    s_cbranch_scc1 L_w41_evt
L_w41_go:
    s_and_b32 m0, s48, 0x1ffff
    s_waitcnt vmcnt(9)
    buffer_load_dwordx4 v8, s[24:27], s21 offen nt lds
    s_add_u32 s42, s42, 1
    s_waitcnt vmcnt(9)
    ds_add_u32 v5, v19
    buffer_load_dwordx4 v9, s[24:27], s21 offen offset:1024 nt lds
    s_add_u32 s48, s48, 0x2000
    s_waitcnt vmcnt(9)
    buffer_load_dwordx4 v10, s[24:27], s21 offen offset:2048 nt lds
    ds_read_b32 v21, v22
    s_waitcnt vmcnt(10)
    buffer_load_dwordx4 v11, s[24:27], s21 offen offset:3072 nt lds
    s_and_b32 m0, s59, 0x1ffff
    s_waitcnt vmcnt(9)
    buffer_load_dwordx4 v12, s[28:31], s58 offen nt lds
    v_readlane_b32 s21, v16, s42
    s_waitcnt vmcnt(9)
    ds_add_u32 v5, v19
    buffer_load_dwordx4 v13, s[28:31], s58 offen offset:1024 nt lds
    s_add_u32 s59, s59, 0x2000
    s_waitcnt vmcnt(9)
    buffer_load_dwordx4 v14, s[28:31], s58 offen offset:2048 nt lds
    s_waitcnt vmcnt(10)
    buffer_load_dwordx4 v15, s[28:31], s58 offen offset:3072 nt lds
    v_readlane_b32 s58, v28, s42
    s_branch L_w41_top
L_w41_evt:
    s_cmp_eq_u32 s42, s44
    s_cbranch_scc1 L_rare
L_w41_slow:
    s_waitcnt lgkmcnt(0)
    v_readlane_b32 s60, v21, 0
    v_readlane_b32 s61, v21, 1
    v_readlane_b32 s62, v21, 2
    v_readlane_b32 s63, v21, 3
    ds_read_b32 v21, v22
    s_min_u32 s60, s60, s61
    s_min_u32 s62, s62, s63
    s_min_u32 s47, s60, s62
    s_add_u32 s47, s47, 16
    s_min_u32 s43, s44, s47
    s_cmp_lt_u32 s42, s47
    s_cbranch_scc1 L_w41_go
    s_branch L_w41_slow
L_w42:
    v_mov_b32 v6, s54
    v_add_u32 v6, -6, v6
    s_waitcnt vmcnt(12)
    ds_write_b32 v5, v6
    s_branch L_w42_evt
L_w42_top:
    s_cmp_ge_u32 s42, s43
    s_cbranch_scc1 L_w42_evt
L_w42_go:
    s_and_b32 m0, s48, 0x1ffff
    s_waitcnt vmcnt(9)
    buffer_load_dwordx4 v8, s[24:27], s21 offen nt lds
    s_add_u32 s42, s42, 1
    s_waitcnt vmcnt(10)
    buffer_load_dwordx4 v9, s[24:27], s21 offen offset:1024 nt lds
    s_add_u32 s48, s48, 0x2000
    s_waitcnt vmcnt(9)
    ds_add_u32 v5, v19
    buffer_load_dwordx4 v10, s[24:27], s21 offen offset:2048 nt lds
    ds_read_b32 v21, v22
    s_waitcnt vmcnt(10)
    buffer_load_dwordx4 v11, s[24:27], s21 offen offset:3072 nt lds
    s_and_b32 m0, s59, 0x1ffff
    s_waitcnt vmcnt(9)
    buffer_load_dwordx4 v12, s[28:31], s58 offen nt lds
    v_readlane_b32 s21, v16, s42
    s_waitcnt vmcnt(10)
    buffer_load_dwordx4 v13, s[28:31], s58 offen offset:1024 nt lds
    s_add_u32 s59, s59, 0x2000
    s_waitcnt vmcnt(9)
    ds_add_u32 v5, v19
    buffer_load_dwordx4 v14, s[28:31], s58 offen offset:2048 nt lds
    s_waitcnt vmcnt(10)
    buffer_load_dwordx4 v15, s[28:31], s58 offen offset:3072 nt lds
    v_readlane_b32 s58, v28, s42
    s_branch L_w42_top
L_w42_evt:
    s_cmp_eq_u32 s42, s44
    s_cbranch_scc1 L_rare
L_w42_slow:
    s_waitcnt lgkmcnt(0)
    v_readlane_b32 s60, v21, 0
    v_readlane_b32 s61, v21, 1
    v_readlane_b32 s62, v21, 2
    v_readlane_b32 s63, v21, 3
    ds_read_b32 v21, v22
    s_min_u32 s60, s60, s61
    s_min_u32 s62, s62, s63
    s_min_u32 s47, s60, s62
    s_add_u32 s47, s47, 16
    s_min_u32 s43, s44, s47
    s_cmp_lt_u32 s42, s47
    s_cbranch_scc1 L_w42_go
    s_branch L_w42_slow
L_w43:
    v_mov_b32 v6, s54
    v_add_u32 v6, -6, v6
    s_waitcnt vmcnt(12)
    ds_write_b32 v5, v6
    s_branch L_w43_evt
L_w43_top:
    s_cmp_ge_u32 s42, s43
    s_cbranch_scc1 L_w43_evt
L_w43_go:
    s_and_b32 m0, s48, 0x1ffff
    s_waitcnt vmcnt(9)
    buffer_load_dwordx4 v8, s[24:27], s21 offen nt lds
    s_add_u32 s42, s42, 1
    s_waitcnt vmcnt(10)
    buffer_load_dwordx4 v9, s[24:27], s21 offen offset:1024 nt lds
    s_add_u32 s48, s48, 0x2000
    s_waitcnt vmcnt(10)
    ds_add_u32 v5, v19
    buffer_load_dwordx4 v10, s[24:27], s21 offen offset:2048 nt lds
    ds_read_b32 v21, v22
    s_waitcnt vmcnt(10)
    buffer_load_dwordx4 v11, s[24:27], s21 offen offset:3072 nt lds
    s_and_b32 m0, s59, 0x1ffff
    s_waitcnt vmcnt(9)
    buffer_load_dwordx4 v12, s[28:31], s58 offen nt lds
    v_readlane_b32 s21, v16, s42
    s_waitcnt vmcnt(10)
    buffer_load_dwordx4 v13, s[28:31], s58 offen offset:1024 nt lds
    s_add_u32 s59, s59, 0x2000
    s_waitcnt vmcnt(10)
    ds_add_u32 v5, v19
    buffer_load_dwordx4 v14, s[28:31], s58 offen offset:2048 nt lds
    s_waitcnt vmcnt(10)
    buffer_load_dwordx4 v15, s[28:31], s58 offen offset:3072 nt lds
    v_readlane_b32 s58, v28, s42
    s_branch L_w43_top
L_w43_evt:
    s_cmp_eq_u32 s42, s44
    s_cbranch_scc1 L_rare
L_w43_slow:
    s_waitcnt lgkmcnt(0)
    v_readlane_b32 s60, v21, 0
    v_readlane_b32 s61, v21, 1
    v_readlane_b32 s62, v21, 2
    v_readlane_b32 s63, v21, 3
    ds_read_b32 v21, v22
    s_min_u32 s60, s60, s61
    s_min_u32 s62, s62, s63
    s_min_u32 s47, s60, s62
    s_add_u32 s47, s47, 16
    s_min_u32 s43, s44, s47
    s_cmp_lt_u32 s42, s47
    s_cbranch_scc1 L_w43_go
    s_branch L_w43_slow
L_w44:
    v_mov_b32 v6, s54
    v_add_u32 v6, -6, v6
    s_waitcnt vmcnt(12)
    ds_write_b32 v5, v6
    s_branch L_w44_evt
L_w44_top:
    s_cmp_ge_u32 s42, s43
    s_cbranch_scc1 L_w44_evt
L_w44_go:
    s_and_b32 m0, s48, 0x1ffff
    s_waitcnt vmcnt(10)
    buffer_load_dwordx4 v8, s[24:27], s21 offen nt lds
    s_add_u32 s42, s42, 1
    s_waitcnt vmcnt(10)
    buffer_load_dwordx4 v9, s[24:27], s21 offen offset:1024 nt lds
    s_add_u32 s48, s48, 0x2000
    s_waitcnt vmcnt(10)
    ds_add_u32 v5, v19
    buffer_load_dwordx4 v10, s[24:27], s21 offen offset:2048 nt lds
    ds_read_b32 v21, v22
    s_waitcnt vmcnt(10)
    buffer_load_dwordx4 v11, s[24:27], s21 offen offset:3072 nt lds
    s_and_b32 m0, s59, 0x1ffff
    s_waitcnt vmcnt(10)
    buffer_load_dwordx4 v12, s[28:31], s58 offen nt lds
    v_readlane_b32 s21, v16, s42
    s_waitcnt vmcnt(10)
    buffer_load_dwordx4 v13, s[28:31], s58 offen offset:1024 nt lds
    s_add_u32 s59, s59, 0x2000
    s_waitcnt vmcnt(10)
    ds_add_u32 v5, v19
    buffer_load_dwordx4 v14, s[28:31], s58 offen offset:2048 nt lds
    s_waitcnt vmcnt(10)
    buffer_load_dwordx4 v15, s[28:31], s58 offen offset:3072 nt lds
    v_readlane_b32 s58, v28, s42
    s_branch L_w44_top
L_w44_evt:
    s_cmp_eq_u32 s42, s44
    s_cbranch_scc1 L_rare
L_w44_slow:
    s_waitcnt lgkmcnt(0)
    v_readlane_b32 s60, v21, 0
    v_readlane_b32 s61, v21, 1
    v_readlane_b32 s62, v21, 2
    v_readlane_b32 s63, v21, 3
    ds_read_b32 v21, v22
    s_min_u32 s60, s60, s61
    s_min_u32 s62, s62, s63
    s_min_u32 s47, s60, s62
    s_add_u32 s47, s47, 16
    s_min_u32 s43, s44, s47
    s_cmp_lt_u32 s42, s47
    s_cbranch_scc1 L_w44_go
    s_branch L_w44_slow
L_w45:
    v_mov_b32 v6, s54
    v_add_u32 v6, -6, v6
    s_waitcnt vmcnt(12)
    ds_write_b32 v5, v6
    s_branch L_w45_evt
L_w45_top:
    s_cmp_ge_u32 s42, s43
    s_cbranch_scc1 L_w45_evt
L_w45_go:
    s_and_b32 m0, s48, 0x1ffff
    s_waitcnt vmcnt(10)
    buffer_load_dwordx4 v8, s[24:27], s21 offen nt lds
    s_add_u32 s42, s42, 1
    s_waitcnt vmcnt(10)
    buffer_load_dwordx4 v9, s[24:27], s21 offen offset:1024 nt lds
    s_add_u32 s48, s48, 0x2000
    s_waitcnt vmcnt(10)
    ds_add_u32 v5, v19
    buffer_load_dwordx4 v10, s[24:27], s21 offen offset:2048 nt lds
    ds_read_b32 v21, v22
    s_waitcnt vmcnt(11)
    buffer_load_dwordx4 v11, s[24:27], s21 offen offset:3072 nt lds
    s_and_b32 m0, s59, 0x1ffff
    s_waitcnt vmcnt(10)
    buffer_load_dwordx4 v12, s[28:31], s58 offen nt lds
    v_readlane_b32 s21, v16, s42
    s_waitcnt vmcnt(10)
    buffer_load_dwordx4 v13, s[28:31], s58 offen offset:1024 nt lds
    s_add_u32 s59, s59, 0x2000
    s_waitcnt vmcnt(10)
    ds_add_u32 v5, v19
    buffer_load_dwordx4 v14, s[28:31], s58 offen offset:2048 nt lds
    s_waitcnt vmcnt(11)
    buffer_load_dwordx4 v15, s[28:31], s58 offen offset:3072 nt lds
    v_readlane_b32 s58, v28, s42
    s_branch L_w45_top
L_w45_evt:
    s_cmp_eq_u32 s42, s44
    s_cbranch_scc1 L_rare
L_w45_slow:
    s_waitcnt lgkmcnt(0)
    v_readlane_b32 s60, v21, 0
    v_readlane_b32 s61, v21, 1
    v_readlane_b32 s62, v21, 2
    v_readlane_b32 s63, v21, 3
    ds_read_b32 v21, v22
    s_min_u32 s60, s60, s61
    s_min_u32 s62, s62, s63
    s_min_u32 s47, s60, s62
    s_add_u32 s47, s47, 16
    s_min_u32 s43, s44, s47
    s_cmp_lt_u32 s42, s47
    s_cbranch_scc1 L_w45_go
    s_branch L_w45_slow
L_w46:
    v_mov_b32 v6, s54
    v_add_u32 v6, -6, v6
    s_waitcnt vmcnt(12)
    ds_write_b32 v5, v6
    s_branch L_w46_evt
L_w46_top:
    s_cmp_ge_u32 s42, s43
    s_cbranch_scc1 L_w46_evt
L_w46_go:
    s_and_b32 m0, s48, 0x1ffff
    s_waitcnt vmcnt(10)
    buffer_load_dwordx4 v8, s[24:27], s21 offen nt lds
    s_add_u32 s42, s42, 1
    s_waitcnt vmcnt(11)
    buffer_load_dwordx4 v9, s[24:27], s21 offen offset:1024 nt lds
    s_add_u32 s48, s48, 0x2000
    s_waitcnt vmcnt(10)
    ds_add_u32 v5, v19
    buffer_load_dwordx4 v10, s[24:27], s21 offen offset:2048 nt lds
    ds_read_b32 v21, v22
    s_waitcnt vmcnt(11)
    buffer_load_dwordx4 v11, s[24:27], s21 offen offset:3072 nt lds
    s_and_b32 m0, s59, 0x1ffff
    s_waitcnt vmcnt(10)
    buffer_load_dwordx4 v12, s[28:31], s58 offen nt lds
    v_readlane_b32 s21, v16, s42
    s_waitcnt vmcnt(11)
    buffer_load_dwordx4 v13, s[28:31], s58 offen offset:1024 nt lds
    s_add_u32 s59, s59, 0x2000
    s_waitcnt vmcnt(10)
    ds_add_u32 v5, v19
    buffer_load_dwordx4 v14, s[28:31], s58 offen offset:2048 nt lds
    s_waitcnt vmcnt(11)
    buffer_load_dwordx4 v15, s[28:31], s58 offen offset:3072 nt lds
    v_readlane_b32 s58, v28, s42
    s_branch L_w46_top
L_w46_evt:
    s_cmp_eq_u32 s42, s44
    s_cbranch_scc1 L_rare
L_w46_slow:
    s_waitcnt lgkmcnt(0)
    v_readlane_b32 s60, v21, 0
    v_readlane_b32 s61, v21, 1
    v_readlane_b32 s62, v21, 2
    v_readlane_b32 s63, v21, 3
    ds_read_b32 v21, v22
    s_min_u32 s60, s60, s61
    s_min_u32 s62, s62, s63
    s_min_u32 s47, s60, s62
    s_add_u32 s47, s47, 16
    s_min_u32 s43, s44, s47
    s_cmp_lt_u32 s42, s47
    s_cbranch_scc1 L_w46_go
    s_branch L_w46_slow
L_w47:
    v_mov_b32 v6, s54
    v_add_u32 v6, -6, v6
    s_waitcnt vmcnt(12)
    ds_write_b32 v5, v6
    s_branch L_w47_evt
L_w47_top:
    s_cmp_ge_u32 s42, s43
    s_cbranch_scc1 L_w47_evt
L_w47_go:
    s_and_b32 m0, s48, 0x1ffff
    s_waitcnt vmcnt(10)
    buffer_load_dwordx4 v8, s[24:27], s21 offen nt lds
    s_add_u32 s42, s42, 1
    s_waitcnt vmcnt(11)
    buffer_load_dwordx4 v9, s[24:27], s21 offen offset:1024 nt lds
    s_add_u32 s48, s48, 0x2000
    s_waitcnt vmcnt(11)
    buffer_load_dwordx4 v10, s[24:27], s21 offen offset:2048 nt lds
    ds_read_b32 v21, v22
    s_waitcnt vmcnt(11)
    ds_add_u32 v5, v19
    buffer_load_dwordx4 v11, s[24:27], s21 offen offset:3072 nt lds
    s_and_b32 m0, s59, 0x1ffff
    s_waitcnt vmcnt(10)
    buffer_load_dwordx4 v12, s[28:31], s58 offen nt lds
    v_readlane_b32 s21, v16, s42
    s_waitcnt vmcnt(11)
    buffer_load_dwordx4 v13, s[28:31], s58 offen offset:1024 nt lds
    s_add_u32 s59, s59, 0x2000
    s_waitcnt vmcnt(11)
    buffer_load_dwordx4 v14, s[28:31], s58 offen offset:2048 nt lds
    s_waitcnt vmcnt(11)
    ds_add_u32 v5, v19
    buffer_load_dwordx4 v15, s[28:31], s58 offen offset:3072 nt lds
    v_readlane_b32 s58, v28, s42
    s_branch L_w47_top
L_w47_evt:
    s_cmp_eq_u32 s42, s44
    s_cbranch_scc1 L_rare
L_w47_slow:
    s_waitcnt lgkmcnt(0)
    v_readlane_b32 s60, v21, 0
    v_readlane_b32 s61, v21, 1
    v_readlane_b32 s62, v21, 2
    v_readlane_b32 s63, v21, 3
    ds_read_b32 v21, v22
    s_min_u32 s60, s60, s61
    s_min_u32 s62, s62, s63
    s_min_u32 s47, s60, s62
    s_add_u32 s47, s47, 16
    s_min_u32 s43, s44, s47
    s_cmp_lt_u32 s42, s47
    s_cbranch_scc1 L_w47_go
    s_branch L_w47_slow
L_w48:
    v_mov_b32 v6, s54
    v_add_u32 v6, -6, v6
    s_waitcnt vmcnt(12)
    ds_write_b32 v5, v6
    s_branch L_w48_evt
L_w48_top:
    s_cmp_ge_u32 s42, s43
    s_cbranch_scc1 L_w48_evt
L_w48_go:
    s_and_b32 m0, s48, 0x1ffff
    s_waitcnt vmcnt(11)
    buffer_load_dwordx4 v8, s[24:27], s21 offen nt lds
    s_add_u32 s42, s42, 1
    s_waitcnt vmcnt(11)
    buffer_load_dwordx4 v9, s[24:27], s21 offen offset:1024 nt lds
    s_add_u32 s48, s48, 0x2000
    s_waitcnt vmcnt(11)
    buffer_load_dwordx4 v10, s[24:27], s21 offen offset:2048 nt lds
    ds_read_b32 v21, v22
    s_waitcnt vmcnt(11)
    ds_add_u32 v5, v19
    buffer_load_dwordx4 v11, s[24:27], s21 offen offset:3072 nt lds
    s_and_b32 m0, s59, 0x1ffff
    s_waitcnt vmcnt(11)
    buffer_load_dwordx4 v12, s[28:31], s58 offen nt lds
    v_readlane_b32 s21, v16, s42
    s_waitcnt vmcnt(11)
    buffer_load_dwordx4 v13, s[28:31], s58 offen offset:1024 nt lds
    s_add_u32 s59, s59, 0x2000
    s_waitcnt vmcnt(11)
    buffer_load_dwordx4 v14, s[28:31], s58 offen offset:2048 nt lds
    s_waitcnt vmcnt(11)
    ds_add_u32 v5, v19
    buffer_load_dwordx4 v15, s[28:31], s58 offen offset:3072 nt lds
    v_readlane_b32 s58, v28, s42
    s_branch L_w48_top
L_w48_evt:
    s_cmp_eq_u32 s42, s44
    s_cbranch_scc1 L_rare
L_w48_slow:
    s_waitcnt lgkmcnt(0)
    v_readlane_b32 s60, v21, 0
    v_readlane_b32 s61, v21, 1
    v_readlane_b32 s62, v21, 2
    v_readlane_b32 s63, v21, 3
    ds_read_b32 v21, v22
    s_min_u32 s60, s60, s61
    s_min_u32 s62, s62, s63
    s_min_u32 s47, s60, s62
    s_add_u32 s47, s47, 16
    s_min_u32 s43, s44, s47
    s_cmp_lt_u32 s42, s47
    s_cbranch_scc1 L_w48_go
    s_branch L_w48_slow
L_w49:
    v_mov_b32 v6, s54
    v_add_u32 v6, -7, v6
    s_waitcnt vmcnt(16)
    ds_write_b32 v5, v6
    s_branch L_w49_evt
L_w49_top:
    s_cmp_ge_u32 s42, s43
    s_cbranch_scc1 L_w49_evt
L_w49_go:
    s_and_b32 m0, s48, 0x1ffff
    s_waitcnt vmcnt(11)
    ds_add_u32 v5, v19
    buffer_load_dwordx4 v8, s[24:27], s21 offen nt lds
    s_add_u32 s42, s42, 1
    s_waitcnt vmcnt(11)
    buffer_load_dwordx4 v9, s[24:27], s21 offen offset:1024 nt lds
    s_add_u32 s48, s48, 0x2000
    s_waitcnt vmcnt(11)
    buffer_load_dwordx4 v10, s[24:27], s21 offen offset:2048 nt lds
    ds_read_b32 v21, v22
    s_waitcnt vmcnt(12)
    buffer_load_dwordx4 v11, s[24:27], s21 offen offset:3072 nt lds
    s_and_b32 m0, s59, 0x1ffff
    s_waitcnt vmcnt(11)
    ds_add_u32 v5, v19
    buffer_load_dwordx4 v12, s[28:31], s58 offen nt lds
    v_readlane_b32 s21, v16, s42
    s_waitcnt vmcnt(11)
    buffer_load_dwordx4 v13, s[28:31], s58 offen offset:1024 nt lds
    s_add_u32 s59, s59, 0x2000
    s_waitcnt vmcnt(11)
    buffer_load_dwordx4 v14, s[28:31], s58 offen offset:2048 nt lds
    s_waitcnt vmcnt(12)
    buffer_load_dwordx4 v15, s[28:31], s58 offen offset:3072 nt lds
    v_readlane_b32 s58, v28, s42
    s_branch L_w49_top
L_w49_evt:
    s_cmp_eq_u32 s42, s44
    s_cbranch_scc1 L_rare
L_w49_slow:
    s_waitcnt lgkmcnt(0)
    v_readlane_b32 s60, v21, 0
    v_readlane_b32 s61, v21, 1
    v_readlane_b32 s62, v21, 2
    v_readlane_b32 s63, v21, 3
    ds_read_b32 v21, v22
    s_min_u32 s60, s60, s61
    s_min_u32 s62, s62, s63
    s_min_u32 s47, s60, s62
    s_add_u32 s47, s47, 16
    s_min_u32 s43, s44, s47
    s_cmp_lt_u32 s42, s47
    s_cbranch_scc1 L_w49_go
    s_branch L_w49_slow
L_w50:
    v_mov_b32 v6, s54
    v_add_u32 v6, -7, v6
    s_waitcnt vmcnt(16)
    ds_write_b32 v5, v6
    s_branch L_w50_evt
L_w50_top:
    s_cmp_ge_u32 s42, s43
    s_cbranch_scc1 L_w50_evt
L_w50_go:
    s_and_b32 m0, s48, 0x1ffff
    s_waitcnt vmcnt(11)
    ds_add_u32 v5, v19
    buffer_load_dwordx4 v8, s[24:27], s21 offen nt lds
    s_add_u32 s42, s42, 1
    s_waitcnt vmcnt(12)
    buffer_load_dwordx4 v9, s[24:27], s21 offen offset:1024 nt lds
    s_add_u32 s48, s48, 0x2000
    s_waitcnt vmcnt(11)
    buffer_load_dwordx4 v10, s[24:27], s21 offen offset:2048 nt lds
    ds_read_b32 v21, v22
    s_waitcnt vmcnt(12)
    buffer_load_dwordx4 v11, s[24:27], s21 offen offset:3072 nt lds
    s_and_b32 m0, s59, 0x1ffff
    s_waitcnt vmcnt(11)
    ds_add_u32 v5, v19
    buffer_load_dwordx4 v12, s[28:31], s58 offen nt lds
    v_readlane_b32 s21, v16, s42
    s_waitcnt vmcnt(12)
    buffer_load_dwordx4 v13, s[28:31], s58 offen offset:1024 nt lds
    s_add_u32 s59, s59, 0x2000
    s_waitcnt vmcnt(11)
    buffer_load_dwordx4 v14, s[28:31], s58 offen offset:2048 nt lds
    s_waitcnt vmcnt(12)
    buffer_load_dwordx4 v15, s[28:31], s58 offen offset:3072 nt lds
    v_readlane_b32 s58, v28, s42
    s_branch L_w50_top
L_w50_evt:
    s_cmp_eq_u32 s42, s44
    s_cbranch_scc1 L_rare
L_w50_slow:
    s_waitcnt lgkmcnt(0)
    v_readlane_b32 s60, v21, 0
    v_readlane_b32 s61, v21, 1
    v_readlane_b32 s62, v21, 2
    v_readlane_b32 s63, v21, 3
    ds_read_b32 v21, v22
    s_min_u32 s60, s60, s61
    s_min_u32 s62, s62, s63
    s_min_u32 s47, s60, s62
    s_add_u32 s47, s47, 16
    s_min_u32 s43, s44, s47
    s_cmp_lt_u32 s42, s47
    s_cbranch_scc1 L_w50_go
    s_branch L_w50_slow
L_w51:
    v_mov_b32 v6, s54
    v_add_u32 v6, -7, v6
    s_waitcnt vmcnt(16)
    ds_write_b32 v5, v6
    s_branch L_w51_evt
L_w51_top:
    s_cmp_ge_u32 s42, s43
    s_cbranch_scc1 L_w51_evt
L_w51_go:
    s_and_b32 m0, s48, 0x1ffff
    s_waitcnt vmcnt(11)
    ds_add_u32 v5, v19
    buffer_load_dwordx4 v8, s[24:27], s21 offen nt lds
    s_add_u32 s42, s42, 1
    s_waitcnt vmcnt(12)
    buffer_load_dwordx4 v9, s[24:27], s21 offen offset:1024 nt lds
    s_add_u32 s48, s48, 0x2000
    s_waitcnt vmcnt(12)
    buffer_load_dwordx4 v10, s[24:27], s21 offen offset:2048 nt lds
    ds_read_b32 v21, v22
    s_waitcnt vmcnt(12)
    buffer_load_dwordx4 v11, s[24:27], s21 offen offset:3072 nt lds
    s_and_b32 m0, s59, 0x1ffff
    s_waitcnt vmcnt(11)
    ds_add_u32 v5, v19
    buffer_load_dwordx4 v12, s[28:31], s58 offen nt lds
    v_readlane_b32 s21, v16, s42
    s_waitcnt vmcnt(12)
    buffer_load_dwordx4 v13, s[28:31], s58 offen offset:1024 nt lds
    s_add_u32 s59, s59, 0x2000
    s_waitcnt vmcnt(12)
    buffer_load_dwordx4 v14, s[28:31], s58 offen offset:2048 nt lds
    s_waitcnt vmcnt(12)
    buffer_load_dwordx4 v15, s[28:31], s58 offen offset:3072 nt lds
    v_readlane_b32 s58, v28, s42
    s_branch L_w51_top
L_w51_evt:
    s_cmp_eq_u32 s42, s44
    s_cbranch_scc1 L_rare
L_w51_slow:
    s_waitcnt lgkmcnt(0)
    v_readlane_b32 s60, v21, 0
    v_readlane_b32 s61, v21, 1
    v_readlane_b32 s62, v21, 2
    v_readlane_b32 s63, v21, 3
    ds_read_b32 v21, v22
    s_min_u32 s60, s60, s61
    s_min_u32 s62, s62, s63
    s_min_u32 s47, s60, s62
    s_add_u32 s47, s47, 16
    s_min_u32 s43, s44, s47
    s_cmp_lt_u32 s42, s47
    s_cbranch_scc1 L_w51_go
    s_branch L_w51_slow
L_w52:
    v_mov_b32 v6, s54
    v_add_u32 v6, -7, v6
    s_waitcnt vmcnt(16)
    ds_write_b32 v5, v6
    s_branch L_w52_evt
L_w52_top:
    s_cmp_ge_u32 s42, s43
    s_cbranch_scc1 L_w52_evt
L_w52_go:
    s_and_b32 m0, s48, 0x1ffff
    s_waitcnt vmcnt(12)
    ds_add_u32 v5, v19
    buffer_load_dwordx4 v8, s[24:27], s21 offen nt lds
    s_add_u32 s42, s42, 1
    s_waitcnt vmcnt(12)
    buffer_load_dwordx4 v9, s[24:27], s21 offen offset:1024 nt lds
    s_add_u32 s48, s48, 0x2000
    s_waitcnt vmcnt(12)
    buffer_load_dwordx4 v10, s[24:27], s21 offen offset:2048 nt lds
    ds_read_b32 v21, v22
    s_waitcnt vmcnt(12)
    buffer_load_dwordx4 v11, s[24:27], s21 offen offset:3072 nt lds
    s_and_b32 m0, s59, 0x1ffff
    s_waitcnt vmcnt(12)
    ds_add_u32 v5, v19
    buffer_load_dwordx4 v12, s[28:31], s58 offen nt lds
    v_readlane_b32 s21, v16, s42
    s_waitcnt vmcnt(12)
    buffer_load_dwordx4 v13, s[28:31], s58 offen offset:1024 nt lds
    s_add_u32 s59, s59, 0x2000
    s_waitcnt vmcnt(12)
    buffer_load_dwordx4 v14, s[28:31], s58 offen offset:2048 nt lds
    s_waitcnt vmcnt(12)
    buffer_load_dwordx4 v15, s[28:31], s58 offen offset:3072 nt lds
    v_readlane_b32 s58, v28, s42
    s_branch L_w52_top
L_w52_evt:
    s_cmp_eq_u32 s42, s44
    s_cbranch_scc1 L_rare
L_w52_slow:
    s_waitcnt lgkmcnt(0)
    v_readlane_b32 s60, v21, 0
    v_readlane_b32 s61, v21, 1
    v_readlane_b32 s62, v21, 2
    v_readlane_b32 s63, v21, 3
    ds_read_b32 v21, v22
    s_min_u32 s60, s60, s61
    s_min_u32 s62, s62, s63
    s_min_u32 s47, s60, s62
    s_add_u32 s47, s47, 16
    s_min_u32 s43, s44, s47
    s_cmp_lt_u32 s42, s47
    s_cbranch_scc1 L_w52_go
    s_branch L_w52_slow
L_w53:
    v_mov_b32 v6, s54
    v_add_u32 v6, -7, v6
    s_waitcnt vmcnt(16)
    ds_write_b32 v5, v6
    s_branch L_w53_evt
L_w53_top:
    s_cmp_ge_u32 s42, s43
    s_cbranch_scc1 L_w53_evt
L_w53_go:
    s_and_b32 m0, s48, 0x1ffff
    s_waitcnt vmcnt(12)
    ds_add_u32 v5, v19
    buffer_load_dwordx4 v8, s[24:27], s21 offen nt lds
    s_add_u32 s42, s42, 1
    s_waitcnt vmcnt(12)
    buffer_load_dwordx4 v9, s[24:27], s21 offen offset:1024 nt lds
    s_add_u32 s48, s48, 0x2000
    s_waitcnt vmcnt(12)
    buffer_load_dwordx4 v10, s[24:27], s21 offen offset:2048 nt lds
    ds_read_b32 v21, v22
    s_waitcnt vmcnt(13)
    buffer_load_dwordx4 v11, s[24:27], s21 offen offset:3072 nt lds
    s_and_b32 m0, s59, 0x1ffff
    s_waitcnt vmcnt(12)
    ds_add_u32 v5, v19
    buffer_load_dwordx4 v12, s[28:31], s58 offen nt lds
    v_readlane_b32 s21, v16, s42
    s_waitcnt vmcnt(12)
    buffer_load_dwordx4 v13, s[28:31], s58 offen offset:1024 nt lds
    s_add_u32 s59, s59, 0x2000
    s_waitcnt vmcnt(12)
    buffer_load_dwordx4 v14, s[28:31], s58 offen offset:2048 nt lds
    s_waitcnt vmcnt(13)
    buffer_load_dwordx4 v15, s[28:31], s58 offen offset:3072 nt lds
    v_readlane_b32 s58, v28, s42
    s_branch L_w53_top
L_w53_evt:
    s_cmp_eq_u32 s42, s44
    s_cbranch_scc1 L_rare
L_w53_slow:
    s_waitcnt lgkmcnt(0)
    v_readlane_b32 s60, v21, 0
    v_readlane_b32 s61, v21, 1
    v_readlane_b32 s62, v21, 2
    v_readlane_b32 s63, v21, 3
    ds_read_b32 v21, v22
    s_min_u32 s60, s60, s61
    s_min_u32 s62, s62, s63
    s_min_u32 s47, s60, s62
    s_add_u32 s47, s47, 16
    s_min_u32 s43, s44, s47
    s_cmp_lt_u32 s42, s47
    s_cbranch_scc1 L_w53_go
    s_branch L_w53_slow
L_w54:
    v_mov_b32 v6, s54
    v_add_u32 v6, -7, v6
    s_waitcnt vmcnt(16)
    ds_write_b32 v5, v6
    s_branch L_w54_evt
L_w54_top:
    s_cmp_ge_u32 s42, s43
    s_cbranch_scc1 L_w54_evt
L_w54_go:
    s_and_b32 m0, s48, 0x1ffff
    s_waitcnt vmcnt(12)
    ds_add_u32 v5, v19
    buffer_load_dwordx4 v8, s[24:27], s21 offen nt lds
    s_add_u32 s42, s42, 1
    s_waitcnt vmcnt(13)
    buffer_load_dwordx4 v9, s[24:27], s21 offen offset:1024 nt lds
    s_add_u32 s48, s48, 0x2000
    s_waitcnt vmcnt(12)
    buffer_load_dwordx4 v10, s[24:27], s21 offen offset:2048 nt lds
    ds_read_b32 v21, v22
    s_waitcnt vmcnt(13)
    buffer_load_dwordx4 v11, s[24:27], s21 offen offset:3072 nt lds
    s_and_b32 m0, s59, 0x1ffff
    s_waitcnt vmcnt(12)
    ds_add_u32 v5, v19
    buffer_load_dwordx4 v12, s[28:31], s58 offen nt lds
    v_readlane_b32 s21, v16, s42
    s_waitcnt vmcnt(13)
    buffer_load_dwordx4 v13, s[28:31], s58 offen offset:1024 nt lds
    s_add_u32 s59, s59, 0x2000
    s_waitcnt vmcnt(12)
    buffer_load_dwordx4 v14, s[28:31], s58 offen offset:2048 nt lds
    s_waitcnt vmcnt(13)
    buffer_load_dwordx4 v15, s[28:31], s58 offen offset:3072 nt lds
    v_readlane_b32 s58, v28, s42
    s_branch L_w54_top
L_w54_evt:
    s_cmp_eq_u32 s42, s44
    s_cbranch_scc1 L_rare
L_w54_slow:
    s_waitcnt lgkmcnt(0)
    v_readlane_b32 s60, v21, 0
    v_readlane_b32 s61, v21, 1
    v_readlane_b32 s62, v21, 2
    v_readlane_b32 s63, v21, 3
    ds_read_b32 v21, v22
    s_min_u32 s60, s60, s61
    s_min_u32 s62, s62, s63
    s_min_u32 s47, s60, s62
    s_add_u32 s47, s47, 16
    s_min_u32 s43, s44, s47
    s_cmp_lt_u32 s42, s47
    s_cbranch_scc1 L_w54_go
    s_branch L_w54_slow
L_w55:
    v_mov_b32 v6, s54
    v_add_u32 v6, -7, v6
    s_waitcnt vmcnt(16)
    ds_write_b32 v5, v6
    s_branch L_w55_evt
L_w55_top:
    s_cmp_ge_u32 s42, s43
    s_cbranch_scc1 L_w55_evt
L_w55_go:
    s_and_b32 m0, s48, 0x1ffff
    s_waitcnt vmcnt(12)
    ds_add_u32 v5, v19
    buffer_load_dwordx4 v8, s[24:27], s21 offen nt lds
    s_add_u32 s42, s42, 1
    s_waitcnt vmcnt(13)
    buffer_load_dwordx4 v9, s[24:27], s21 offen offset:1024 nt lds
    s_add_u32 s48, s48, 0x2000
    s_waitcnt vmcnt(13)
    buffer_load_dwordx4 v10, s[24:27], s21 offen offset:2048 nt lds
    ds_read_b32 v21, v22
    s_waitcnt vmcnt(13)
    buffer_load_dwordx4 v11, s[24:27], s21 offen offset:3072 nt lds
    s_and_b32 m0, s59, 0x1ffff
    s_waitcnt vmcnt(12)
    ds_add_u32 v5, v19
    buffer_load_dwordx4 v12, s[28:31], s58 offen nt lds
    v_readlane_b32 s21, v16, s42
    s_waitcnt vmcnt(13)
    buffer_load_dwordx4 v13, s[28:31], s58 offen offset:1024 nt lds
    s_add_u32 s59, s59, 0x2000
    s_waitcnt vmcnt(13)
    buffer_load_dwordx4 v14, s[28:31], s58 offen offset:2048 nt lds
    s_waitcnt vmcnt(13)
    buffer_load_dwordx4 v15, s[28:31], s58 offen offset:3072 nt lds
    v_readlane_b32 s58, v28, s42
    s_branch L_w55_top
L_w55_evt:
    s_cmp_eq_u32 s42, s44
    s_cbranch_scc1 L_rare
L_w55_slow:
    s_waitcnt lgkmcnt(0)
    v_readlane_b32 s60, v21, 0
    v_readlane_b32 s61, v21, 1
    v_readlane_b32 s62, v21, 2
    v_readlane_b32 s63, v21, 3
    ds_read_b32 v21, v22
    s_min_u32 s60, s60, s61
    s_min_u32 s62, s62, s63
    s_min_u32 s47, s60, s62
    s_add_u32 s47, s47, 16
    s_min_u32 s43, s44, s47
    s_cmp_lt_u32 s42, s47
    s_cbranch_scc1 L_w55_go
    s_branch L_w55_slow
L_w56:
    v_mov_b32 v6, s54
    v_add_u32 v6, -7, v6
    s_waitcnt vmcnt(16)
    ds_write_b32 v5, v6
    s_branch L_w56_evt
L_w56_top:
    s_cmp_ge_u32 s42, s43
    s_cbranch_scc1 L_w56_evt
L_w56_go:
    s_and_b32 m0, s48, 0x1ffff
    s_waitcnt vmcnt(13)
    buffer_load_dwordx4 v8, s[24:27], s21 offen nt lds
    s_add_u32 s42, s42, 1
    s_waitcnt vmcnt(13)
    ds_add_u32 v5, v19
    buffer_load_dwordx4 v9, s[24:27], s21 offen offset:1024 nt lds
    s_add_u32 s48, s48, 0x2000
    s_waitcnt vmcnt(13)
    buffer_load_dwordx4 v10, s[24:27], s21 offen offset:2048 nt lds
    ds_read_b32 v21, v22
    s_waitcnt vmcnt(13)
    buffer_load_dwordx4 v11, s[24:27], s21 offen offset:3072 nt lds
    s_and_b32 m0, s59, 0x1ffff
    s_waitcnt vmcnt(13)
    buffer_load_dwordx4 v12, s[28:31], s58 offen nt lds
    v_readlane_b32 s21, v16, s42
    s_waitcnt vmcnt(13)
    ds_add_u32 v5, v19
    buffer_load_dwordx4 v13, s[28:31], s58 offen offset:1024 nt lds
    s_add_u32 s59, s59, 0x2000
    s_waitcnt vmcnt(13)
    buffer_load_dwordx4 v14, s[28:31], s58 offen offset:2048 nt lds
    s_waitcnt vmcnt(13)
    buffer_load_dwordx4 v15, s[28:31], s58 offen offset:3072 nt lds
    v_readlane_b32 s58, v28, s42
    s_branch L_w56_top
L_w56_evt:
    s_cmp_eq_u32 s42, s44
    s_cbranch_scc1 L_rare
L_w56_slow:
    s_waitcnt lgkmcnt(0)
    v_readlane_b32 s60, v21, 0
    v_readlane_b32 s61, v21, 1
    v_readlane_b32 s62, v21, 2
    v_readlane_b32 s63, v21, 3
    ds_read_b32 v21, v22
    s_min_u32 s60, s60, s61
    s_min_u32 s62, s62, s63
    s_min_u32 s47, s60, s62
    s_add_u32 s47, s47, 16
    s_min_u32 s43, s44, s47
    s_cmp_lt_u32 s42, s47
    s_cbranch_scc1 L_w56_go
    s_branch L_w56_slow
L_w57:
    v_mov_b32 v6, s54
    v_add_u32 v6, -7, v6
    s_waitcnt vmcnt(16)
    ds_write_b32 v5, v6
    s_branch L_w57_evt
L_w57_top:
    s_cmp_ge_u32 s42, s43
    s_cbranch_scc1 L_w57_evt
L_w57_go:
    s_and_b32 m0, s48, 0x1ffff
    s_waitcnt vmcnt(13)
    buffer_load_dwordx4 v8, s[24:27], s21 offen nt lds
    s_add_u32 s42, s42, 1
    s_waitcnt vmcnt(13)
    ds_add_u32 v5, v19
    buffer_load_dwordx4 v9, s[24:27], s21 offen offset:1024 nt lds
    s_add_u32 s48, s48, 0x2000
    s_waitcnt vmcnt(13)
    buffer_load_dwordx4 v10, s[24:27], s21 offen offset:2048 nt lds
    ds_read_b32 v21, v22
    s_waitcnt vmcnt(14)
    buffer_load_dwordx4 v11, s[24:27], s21 offen offset:3072 nt lds
    s_and_b32 m0, s59, 0x1ffff
    s_waitcnt vmcnt(13)
    buffer_load_dwordx4 v12, s[28:31], s58 offen nt lds
    v_readlane_b32 s21, v16, s42
    s_waitcnt vmcnt(13)
    ds_add_u32 v5, v19
    buffer_load_dwordx4 v13, s[28:31], s58 offen offset:1024 nt lds
    s_add_u32 s59, s59, 0x2000
    s_waitcnt vmcnt(13)
    buffer_load_dwordx4 v14, s[28:31], s58 offen offset:2048 nt lds
    s_waitcnt vmcnt(14)
    buffer_load_dwordx4 v15, s[28:31], s58 offen offset:3072 nt lds
    v_readlane_b32 s58, v28, s42
    s_branch L_w57_top
L_w57_evt:
    s_cmp_eq_u32 s42, s44
    s_cbranch_scc1 L_rare
L_w57_slow:
    s_waitcnt lgkmcnt(0)
    v_readlane_b32 s60, v21, 0
    v_readlane_b32 s61, v21, 1
    v_readlane_b32 s62, v21, 2
    v_readlane_b32 s63, v21, 3
    ds_read_b32 v21, v22
    s_min_u32 s60, s60, s61
    s_min_u32 s62, s62, s63
    s_min_u32 s47, s60, s62
    s_add_u32 s47, s47, 16
    s_min_u32 s43, s44, s47
    s_cmp_lt_u32 s42, s47
    s_cbranch_scc1 L_w57_go
    s_branch L_w57_slow
L_w58:
    v_mov_b32 v6, s54
    v_add_u32 v6, -7, v6
    s_waitcnt vmcnt(16)
    ds_write_b32 v5, v6
    s_branch L_w58_evt
L_w58_top:
    s_cmp_ge_u32 s42, s43
    s_cbranch_scc1 L_w58_evt
L_w58_go:
    s_and_b32 m0, s48, 0x1ffff
    s_waitcnt vmcnt(13)
    buffer_load_dwordx4 v8, s[24:27], s21 offen nt lds
    s_add_u32 s42, s42, 1
    s_waitcnt vmcnt(14)
    buffer_load_dwordx4 v9, s[24:27], s21 offen offset:1024 nt lds
    s_add_u32 s48, s48, 0x2000
    s_waitcnt vmcnt(13)
    ds_add_u32 v5, v19
    buffer_load_dwordx4 v10, s[24:27], s21 offen offset:2048 nt lds
    ds_read_b32 v21, v22
    s_waitcnt vmcnt(14)
    buffer_load_dwordx4 v11, s[24:27], s21 offen offset:3072 nt lds
    s_and_b32 m0, s59, 0x1ffff
    s_waitcnt vmcnt(13)
    buffer_load_dwordx4 v12, s[28:31], s58 offen nt lds
    v_readlane_b32 s21, v16, s42
    s_waitcnt vmcnt(14)
    buffer_load_dwordx4 v13, s[28:31], s58 offen offset:1024 nt lds
    s_add_u32 s59, s59, 0x2000
    s_waitcnt vmcnt(13)
    ds_add_u32 v5, v19
    buffer_load_dwordx4 v14, s[28:31], s58 offen offset:2048 nt lds
    s_waitcnt vmcnt(14)
    buffer_load_dwordx4 v15, s[28:31], s58 offen offset:3072 nt lds
    v_readlane_b32 s58, v28, s42
    s_branch L_w58_top
L_w58_evt:
    s_cmp_eq_u32 s42, s44
    s_cbranch_scc1 L_rare
L_w58_slow:
    s_waitcnt lgkmcnt(0)
    v_readlane_b32 s60, v21, 0
    v_readlane_b32 s61, v21, 1
    v_readlane_b32 s62, v21, 2
    v_readlane_b32 s63, v21, 3
    ds_read_b32 v21, v22
    s_min_u32 s60, s60, s61
    s_min_u32 s62, s62, s63
    s_min_u32 s47, s60, s62
    s_add_u32 s47, s47, 16
    s_min_u32 s43, s44, s47
    s_cmp_lt_u32 s42, s47
    s_cbranch_scc1 L_w58_go
    s_branch L_w58_slow
L_w59:
    v_mov_b32 v6, s54
    v_add_u32 v6, -7, v6
    s_waitcnt vmcnt(16)
    ds_write_b32 v5, v6
    s_branch L_w59_evt
L_w59_top:
    s_cmp_ge_u32 s42, s43
    s_cbranch_scc1 L_w59_evt
L_w59_go:
    s_and_b32 m0, s48, 0x1ffff
    s_waitcnt vmcnt(13)
    buffer_load_dwordx4 v8, s[24:27], s21 offen nt lds
    s_add_u32 s42, s42, 1
    s_waitcnt vmcnt(14)
    buffer_load_dwordx4 v9, s[24:27], s21 offen offset:1024 nt lds
    s_add_u32 s48, s48, 0x2000
    s_waitcnt vmcnt(14)
    ds_add_u32 v5, v19
    buffer_load_dwordx4 v10, s[24:27], s21 offen offset:2048 nt lds
    ds_read_b32 v21, v22
    s_waitcnt vmcnt(14)
    buffer_load_dwordx4 v11, s[24:27], s21 offen offset:3072 nt lds
    s_and_b32 m0, s59, 0x1ffff
    s_waitcnt vmcnt(13)
    buffer_load_dwordx4 v12, s[28:31], s58 offen nt lds
    v_readlane_b32 s21, v16, s42
    s_waitcnt vmcnt(14)
    buffer_load_dwordx4 v13, s[28:31], s58 offen offset:1024 nt lds
    s_add_u32 s59, s59, 0x2000
    s_waitcnt vmcnt(14)
    ds_add_u32 v5, v19
    buffer_load_dwordx4 v14, s[28:31], s58 offen offset:2048 nt lds
    s_waitcnt vmcnt(14)
    buffer_load_dwordx4 v15, s[28:31], s58 offen offset:3072 nt lds
    v_readlane_b32 s58, v28, s42
    s_branch L_w59_top
L_w59_evt:
    s_cmp_eq_u32 s42, s44
    s_cbranch_scc1 L_rare
L_w59_slow:
    s_waitcnt lgkmcnt(0)
    v_readlane_b32 s60, v21, 0
    v_readlane_b32 s61, v21, 1
    v_readlane_b32 s62, v21, 2
    v_readlane_b32 s63, v21, 3
    ds_read_b32 v21, v22
    s_min_u32 s60, s60, s61
    s_min_u32 s62, s62, s63
    s_min_u32 s47, s60, s62
    s_add_u32 s47, s47, 16
    s_min_u32 s43, s44, s47
    s_cmp_lt_u32 s42, s47
    s_cbranch_scc1 L_w59_go
    s_branch L_w59_slow
L_w60:
    v_mov_b32 v6, s54
    v_add_u32 v6, -7, v6
    s_waitcnt vmcnt(16)
    ds_write_b32 v5, v6
    s_branch L_w60_evt
L_w60_top:
    s_cmp_ge_u32 s42, s43
    s_cbranch_scc1 L_w60_evt
L_w60_go:
    s_and_b32 m0, s48, 0x1ffff
    s_waitcnt vmcnt(14)
    buffer_load_dwordx4 v8, s[24:27], s21 offen nt lds
    s_add_u32 s42, s42, 1
    s_waitcnt vmcnt(14)
    buffer_load_dwordx4 v9, s[24:27], s21 offen offset:1024 nt lds
    s_add_u32 s48, s48, 0x2000
    s_waitcnt vmcnt(14)
    ds_add_u32 v5, v19
    buffer_load_dwordx4 v10, s[24:27], s21 offen offset:2048 nt lds
    ds_read_b32 v21, v22
    s_waitcnt vmcnt(14)
    buffer_load_dwordx4 v11, s[24:27], s21 offen offset:3072 nt lds
    s_and_b32 m0, s59, 0x1ffff
    s_waitcnt vmcnt(14)
    buffer_load_dwordx4 v12, s[28:31], s58 offen nt lds
    v_readlane_b32 s21, v16, s42
    s_waitcnt vmcnt(14)
    buffer_load_dwordx4 v13, s[28:31], s58 offen offset:1024 nt lds
    s_add_u32 s59, s59, 0x2000
    s_waitcnt vmcnt(14)
    ds_add_u32 v5, v19
    buffer_load_dwordx4 v14, s[28:31], s58 offen offset:2048 nt lds
    s_waitcnt vmcnt(14)
    buffer_load_dwordx4 v15, s[28:31], s58 offen offset:3072 nt lds
    v_readlane_b32 s58, v28, s42
    s_branch L_w60_top
L_w60_evt:
    s_cmp_eq_u32 s42, s44
    s_cbranch_scc1 L_rare
L_w60_slow:
    s_waitcnt lgkmcnt(0)
    v_readlane_b32 s60, v21, 0
    v_readlane_b32 s61, v21, 1
    v_readlane_b32 s62, v21, 2
    v_readlane_b32 s63, v21, 3
    ds_read_b32 v21, v22
    s_min_u32 s60, s60, s61
    s_min_u32 s62, s62, s63
    s_min_u32 s47, s60, s62
    s_add_u32 s47, s47, 16
    s_min_u32 s43, s44, s47
    s_cmp_lt_u32 s42, s47
    s_cbranch_scc1 L_w60_go
    s_branch L_w60_slow
L_w61:
    v_mov_b32 v6, s54
    v_add_u32 v6, -7, v6
    s_waitcnt vmcnt(16)
    ds_write_b32 v5, v6
    s_branch L_w61_evt
L_w61_top:
    s_cmp_ge_u32 s42, s43
    s_cbranch_scc1 L_w61_evt
L_w61_go:
    s_and_b32 m0, s48, 0x1ffff
    s_waitcnt vmcnt(14)
    buffer_load_dwordx4 v8, s[24:27], s21 offen nt lds
    s_add_u32 s42, s42, 1
    s_waitcnt vmcnt(14)
    buffer_load_dwordx4 v9, s[24:27], s21 offen offset:1024 nt lds
    s_add_u32 s48, s48, 0x2000
    s_waitcnt vmcnt(14)
    ds_add_u32 v5, v19
    buffer_load_dwordx4 v10, s[24:27], s21 offen offset:2048 nt lds
    ds_read_b32 v21, v22
    s_waitcnt vmcnt(15)
    buffer_load_dwordx4 v11, s[24:27], s21 offen offset:3072 nt lds
    s_and_b32 m0, s59, 0x1ffff
    s_waitcnt vmcnt(14)
    buffer_load_dwordx4 v12, s[28:31], s58 offen nt lds
    v_readlane_b32 s21, v16, s42
    s_waitcnt vmcnt(14)
    buffer_load_dwordx4 v13, s[28:31], s58 offen offset:1024 nt lds
    s_add_u32 s59, s59, 0x2000
    s_waitcnt vmcnt(14)
    ds_add_u32 v5, v19
    buffer_load_dwordx4 v14, s[28:31], s58 offen offset:2048 nt lds
    s_waitcnt vmcnt(15)
    buffer_load_dwordx4 v15, s[28:31], s58 offen offset:3072 nt lds
    v_readlane_b32 s58, v28, s42
    s_branch L_w61_top
L_w61_evt:
    s_cmp_eq_u32 s42, s44
    s_cbranch_scc1 L_rare
L_w61_slow:
    s_waitcnt lgkmcnt(0)
    v_readlane_b32 s60, v21, 0
    v_readlane_b32 s61, v21, 1
    v_readlane_b32 s62, v21, 2
    v_readlane_b32 s63, v21, 3
    ds_read_b32 v21, v22
    s_min_u32 s60, s60, s61
    s_min_u32 s62, s62, s63
    s_min_u32 s47, s60, s62
    s_add_u32 s47, s47, 16
    s_min_u32 s43, s44, s47
    s_cmp_lt_u32 s42, s47
    s_cbranch_scc1 L_w61_go
    s_branch L_w61_slow
L_w62:
    v_mov_b32 v6, s54
    v_add_u32 v6, -7, v6
    s_waitcnt vmcnt(16)
    ds_write_b32 v5, v6
    s_branch L_w62_evt
L_w62_top:
    s_cmp_ge_u32 s42, s43
    s_cbranch_scc1 L_w62_evt
L_w62_go:
    s_and_b32 m0, s48, 0x1ffff
    s_waitcnt vmcnt(14)
    buffer_load_dwordx4 v8, s[24:27], s21 offen nt lds
    s_add_u32 s42, s42, 1
    s_waitcnt vmcnt(15)
    buffer_load_dwordx4 v9, s[24:27], s21 offen offset:1024 nt lds
    s_add_u32 s48, s48, 0x2000
    s_waitcnt vmcnt(14)
    ds_add_u32 v5, v19
    buffer_load_dwordx4 v10, s[24:27], s21 offen offset:2048 nt lds
    ds_read_b32 v21, v22
    s_waitcnt vmcnt(15)
    buffer_load_dwordx4 v11, s[24:27], s21 offen offset:3072 nt lds
    s_and_b32 m0, s59, 0x1ffff
    s_waitcnt vmcnt(14)
    buffer_load_dwordx4 v12, s[28:31], s58 offen nt lds
    v_readlane_b32 s21, v16, s42
    s_waitcnt vmcnt(15)
    buffer_load_dwordx4 v13, s[28:31], s58 offen offset:1024 nt lds
    s_add_u32 s59, s59, 0x2000
    s_waitcnt vmcnt(14)
    ds_add_u32 v5, v19
    buffer_load_dwordx4 v14, s[28:31], s58 offen offset:2048 nt lds
    s_waitcnt vmcnt(15)
    buffer_load_dwordx4 v15, s[28:31], s58 offen offset:3072 nt lds
    v_readlane_b32 s58, v28, s42
    s_branch L_w62_top
L_w62_evt:
    s_cmp_eq_u32 s42, s44
    s_cbranch_scc1 L_rare
L_w62_slow:
    s_waitcnt lgkmcnt(0)
    v_readlane_b32 s60, v21, 0
    v_readlane_b32 s61, v21, 1
    v_readlane_b32 s62, v21, 2
    v_readlane_b32 s63, v21, 3
    ds_read_b32 v21, v22
    s_min_u32 s60, s60, s61
    s_min_u32 s62, s62, s63
    s_min_u32 s47, s60, s62
    s_add_u32 s47, s47, 16
    s_min_u32 s43, s44, s47
    s_cmp_lt_u32 s42, s47
    s_cbranch_scc1 L_w62_go
    s_branch L_w62_slow
L_w63:
    v_mov_b32 v6, s54
    v_add_u32 v6, -7, v6
    s_waitcnt vmcnt(16)
    ds_write_b32 v5, v6
    s_branch L_w63_evt
L_w63_top:
    s_cmp_ge_u32 s42, s43
    s_cbranch_scc1 L_w63_evt
L_w63_go:
    s_and_b32 m0, s48, 0x1ffff
    s_waitcnt vmcnt(14)
    buffer_load_dwordx4 v8, s[24:27], s21 offen nt lds
    s_add_u32 s42, s42, 1
    s_waitcnt vmcnt(15)
    buffer_load_dwordx4 v9, s[24:27], s21 offen offset:1024 nt lds
    s_add_u32 s48, s48, 0x2000
    s_waitcnt vmcnt(15)
    buffer_load_dwordx4 v10, s[24:27], s21 offen offset:2048 nt lds
    ds_read_b32 v21, v22
    s_waitcnt vmcnt(15)
    ds_add_u32 v5, v19
    buffer_load_dwordx4 v11, s[24:27], s21 offen offset:3072 nt lds
    s_and_b32 m0, s59, 0x1ffff
    s_waitcnt vmcnt(14)
    buffer_load_dwordx4 v12, s[28:31], s58 offen nt lds
    v_readlane_b32 s21, v16, s42
    s_waitcnt vmcnt(15)
    buffer_load_dwordx4 v13, s[28:31], s58 offen offset:1024 nt lds
    s_add_u32 s59, s59, 0x2000
    s_waitcnt vmcnt(15)
    buffer_load_dwordx4 v14, s[28:31], s58 offen offset:2048 nt lds
    s_waitcnt vmcnt(15)
    ds_add_u32 v5, v19
    buffer_load_dwordx4 v15, s[28:31], s58 offen offset:3072 nt lds
    v_readlane_b32 s58, v28, s42
    s_branch L_w63_top
L_w63_evt:
    s_cmp_eq_u32 s42, s44
    s_cbranch_scc1 L_rare
L_w63_slow:
    s_waitcnt lgkmcnt(0)
    v_readlane_b32 s60, v21, 0
    v_readlane_b32 s61, v21, 1
    v_readlane_b32 s62, v21, 2
    v_readlane_b32 s63, v21, 3
    ds_read_b32 v21, v22
    s_min_u32 s60, s60, s61
    s_min_u32 s62, s62, s63
    s_min_u32 s47, s60, s62
    s_add_u32 s47, s47, 16
    s_min_u32 s43, s44, s47
    s_cmp_lt_u32 s42, s47
    s_cbranch_scc1 L_w63_go
    s_branch L_w63_slow
L_w64:
    v_mov_b32 v6, s54
    v_add_u32 v6, -7, v6
    s_waitcnt vmcnt(16)
    ds_write_b32 v5, v6
    s_branch L_w64_evt
L_w64_top:
    s_cmp_ge_u32 s42, s43
    s_cbranch_scc1 L_w64_evt
L_w64_go:
    s_and_b32 m0, s48, 0x1ffff
    s_waitcnt vmcnt(15)
    buffer_load_dwordx4 v8, s[24:27], s21 offen nt lds
    s_add_u32 s42, s42, 1
    s_waitcnt vmcnt(15)
    buffer_load_dwordx4 v9, s[24:27], s21 offen offset:1024 nt lds
    s_add_u32 s48, s48, 0x2000
    s_waitcnt vmcnt(15)
    buffer_load_dwordx4 v10, s[24:27], s21 offen offset:2048 nt lds
    ds_read_b32 v21, v22
    s_waitcnt vmcnt(15)
    ds_add_u32 v5, v19
    buffer_load_dwordx4 v11, s[24:27], s21 offen offset:3072 nt lds
    s_and_b32 m0, s59, 0x1ffff
    s_waitcnt vmcnt(15)
    buffer_load_dwordx4 v12, s[28:31], s58 offen nt lds
    v_readlane_b32 s21, v16, s42
    s_waitcnt vmcnt(15)
    buffer_load_dwordx4 v13, s[28:31], s58 offen offset:1024 nt lds
    s_add_u32 s59, s59, 0x2000
    s_waitcnt vmcnt(15)
    buffer_load_dwordx4 v14, s[28:31], s58 offen offset:2048 nt lds
    s_waitcnt vmcnt(15)
    ds_add_u32 v5, v19
    buffer_load_dwordx4 v15, s[28:31], s58 offen offset:3072 nt lds
    v_readlane_b32 s58, v28, s42
    s_branch L_w64_top
L_w64_evt:
    s_cmp_eq_u32 s42, s44
    s_cbranch_scc1 L_rare
L_w64_slow:
    s_waitcnt lgkmcnt(0)
    v_readlane_b32 s60, v21, 0
    v_readlane_b32 s61, v21, 1
    v_readlane_b32 s62, v21, 2
    v_readlane_b32 s63, v21, 3
    ds_read_b32 v21, v22
    s_min_u32 s60, s60, s61
    s_min_u32 s62, s62, s63
    s_min_u32 s47, s60, s62
    s_add_u32 s47, s47, 16
    s_min_u32 s43, s44, s47
    s_cmp_lt_u32 s42, s47
    s_cbranch_scc1 L_w64_go
    s_branch L_w64_slow
L_w65:
    v_mov_b32 v6, s54
    v_add_u32 v6, -8, v6
    s_waitcnt vmcnt(20)
    ds_write_b32 v5, v6
    s_branch L_w65_evt
L_w65_top:
    s_cmp_ge_u32 s42, s43
    s_cbranch_scc1 L_w65_evt
L_w65_go:
    s_and_b32 m0, s48, 0x1ffff
    s_waitcnt vmcnt(15)
    ds_add_u32 v5, v19
    buffer_load_dwordx4 v8, s[24:27], s21 offen nt lds
    s_add_u32 s42, s42, 1
    s_waitcnt vmcnt(15)
    buffer_load_dwordx4 v9, s[24:27], s21 offen offset:1024 nt lds
    s_add_u32 s48, s48, 0x2000
    s_waitcnt vmcnt(15)
    buffer_load_dwordx4 v10, s[24:27], s21 offen offset:2048 nt lds
    ds_read_b32 v21, v22
    s_waitcnt vmcnt(16)
    buffer_load_dwordx4 v11, s[24:27], s21 offen offset:3072 nt lds
    s_and_b32 m0, s59, 0x1ffff
    s_waitcnt vmcnt(15)
    ds_add_u32 v5, v19
    buffer_load_dwordx4 v12, s[28:31], s58 offen nt lds
    v_readlane_b32 s21, v16, s42
    s_waitcnt vmcnt(15)
    buffer_load_dwordx4 v13, s[28:31], s58 offen offset:1024 nt lds
    s_add_u32 s59, s59, 0x2000
    s_waitcnt vmcnt(15)
    buffer_load_dwordx4 v14, s[28:31], s58 offen offset:2048 nt lds
    s_waitcnt vmcnt(16)
    buffer_load_dwordx4 v15, s[28:31], s58 offen offset:3072 nt lds
    v_readlane_b32 s58, v28, s42
    s_branch L_w65_top
L_w65_evt:
    s_cmp_eq_u32 s42, s44
    s_cbranch_scc1 L_rare
L_w65_slow:
    s_waitcnt lgkmcnt(0)
    v_readlane_b32 s60, v21, 0
    v_readlane_b32 s61, v21, 1
    v_readlane_b32 s62, v21, 2
    v_readlane_b32 s63, v21, 3
    ds_read_b32 v21, v22
    s_min_u32 s60, s60, s61
    s_min_u32 s62, s62, s63
    s_min_u32 s47, s60, s62
    s_add_u32 s47, s47, 16
    s_min_u32 s43, s44, s47
    s_cmp_lt_u32 s42, s47
    s_cbranch_scc1 L_w65_go
    s_branch L_w65_slow
L_w66:
    v_mov_b32 v6, s54
    v_add_u32 v6, -8, v6
    s_waitcnt vmcnt(20)
    ds_write_b32 v5, v6
    s_branch L_w66_evt
L_w66_top:
    s_cmp_ge_u32 s42, s43
    s_cbranch_scc1 L_w66_evt
L_w66_go:
    s_and_b32 m0, s48, 0x1ffff
    s_waitcnt vmcnt(15)
    ds_add_u32 v5, v19
    buffer_load_dwordx4 v8, s[24:27], s21 offen nt lds
    s_add_u32 s42, s42, 1
    s_waitcnt vmcnt(16)
    buffer_load_dwordx4 v9, s[24:27], s21 offen offset:1024 nt lds
    s_add_u32 s48, s48, 0x2000
    s_waitcnt vmcnt(15)
    buffer_load_dwordx4 v10, s[24:27], s21 offen offset:2048 nt lds
    ds_read_b32 v21, v22
    s_waitcnt vmcnt(16)
    buffer_load_dwordx4 v11, s[24:27], s21 offen offset:3072 nt lds
    s_and_b32 m0, s59, 0x1ffff
    s_waitcnt vmcnt(15)
    ds_add_u32 v5, v19
    buffer_load_dwordx4 v12, s[28:31], s58 offen nt lds
    v_readlane_b32 s21, v16, s42
    s_waitcnt vmcnt(16)
    buffer_load_dwordx4 v13, s[28:31], s58 offen offset:1024 nt lds
    s_add_u32 s59, s59, 0x2000
    s_waitcnt vmcnt(15)
    buffer_load_dwordx4 v14, s[28:31], s58 offen offset:2048 nt lds
    s_waitcnt vmcnt(16)
    buffer_load_dwordx4 v15, s[28:31], s58 offen offset:3072 nt lds
    v_readlane_b32 s58, v28, s42
    s_branch L_w66_top
L_w66_evt:
    s_cmp_eq_u32 s42, s44
    s_cbranch_scc1 L_rare
L_w66_slow:
    s_waitcnt lgkmcnt(0)
    v_readlane_b32 s60, v21, 0
    v_readlane_b32 s61, v21, 1
    v_readlane_b32 s62, v21, 2
    v_readlane_b32 s63, v21, 3
    ds_read_b32 v21, v22
    s_min_u32 s60, s60, s61
    s_min_u32 s62, s62, s63
    s_min_u32 s47, s60, s62
    s_add_u32 s47, s47, 16
    s_min_u32 s43, s44, s47
    s_cmp_lt_u32 s42, s47
    s_cbranch_scc1 L_w66_go
    s_branch L_w66_slow
L_w67:
    v_mov_b32 v6, s54
    v_add_u32 v6, -8, v6
    s_waitcnt vmcnt(20)
    ds_write_b32 v5, v6
    s_branch L_w67_evt
L_w67_top:
    s_cmp_ge_u32 s42, s43
    s_cbranch_scc1 L_w67_evt
L_w67_go:
    s_and_b32 m0, s48, 0x1ffff
    s_waitcnt vmcnt(15)
    ds_add_u32 v5, v19
    buffer_load_dwordx4 v8, s[24:27], s21 offen nt lds
    s_add_u32 s42, s42, 1
    s_waitcnt vmcnt(16)
    buffer_load_dwordx4 v9, s[24:27], s21 offen offset:1024 nt lds
    s_add_u32 s48, s48, 0x2000
    s_waitcnt vmcnt(16)
    buffer_load_dwordx4 v10, s[24:27], s21 offen offset:2048 nt lds
    ds_read_b32 v21, v22
    s_waitcnt vmcnt(16)
    buffer_load_dwordx4 v11, s[24:27], s21 offen offset:3072 nt lds
    s_and_b32 m0, s59, 0x1ffff
    s_waitcnt vmcnt(15)
    ds_add_u32 v5, v19
    buffer_load_dwordx4 v12, s[28:31], s58 offen nt lds
    v_readlane_b32 s21, v16, s42
    s_waitcnt vmcnt(16)
    buffer_load_dwordx4 v13, s[28:31], s58 offen offset:1024 nt lds
    s_add_u32 s59, s59, 0x2000
    s_waitcnt vmcnt(16)
    buffer_load_dwordx4 v14, s[28:31], s58 offen offset:2048 nt lds
    s_waitcnt vmcnt(16)
    buffer_load_dwordx4 v15, s[28:31], s58 offen offset:3072 nt lds
    v_readlane_b32 s58, v28, s42
    s_branch L_w67_top
L_w67_evt:
    s_cmp_eq_u32 s42, s44
    s_cbranch_scc1 L_rare
L_w67_slow:
    s_waitcnt lgkmcnt(0)
    v_readlane_b32 s60, v21, 0
    v_readlane_b32 s61, v21, 1
    v_readlane_b32 s62, v21, 2
    v_readlane_b32 s63, v21, 3
    ds_read_b32 v21, v22
    s_min_u32 s60, s60, s61
    s_min_u32 s62, s62, s63
    s_min_u32 s47, s60, s62
    s_add_u32 s47, s47, 16
    s_min_u32 s43, s44, s47
    s_cmp_lt_u32 s42, s47
    s_cbranch_scc1 L_w67_go
    s_branch L_w67_slow
L_w68:
    v_mov_b32 v6, s54
    v_add_u32 v6, -8, v6
    s_waitcnt vmcnt(20)
    ds_write_b32 v5, v6
    s_branch L_w68_evt
L_w68_top:
    s_cmp_ge_u32 s42, s43
    s_cbranch_scc1 L_w68_evt
L_w68_go:
    s_and_b32 m0, s48, 0x1ffff
    s_waitcnt vmcnt(16)
    ds_add_u32 v5, v19
    buffer_load_dwordx4 v8, s[24:27], s21 offen nt lds
    s_add_u32 s42, s42, 1
    s_waitcnt vmcnt(16)
    buffer_load_dwordx4 v9, s[24:27], s21 offen offset:1024 nt lds
    s_add_u32 s48, s48, 0x2000
    s_waitcnt vmcnt(16)
    buffer_load_dwordx4 v10, s[24:27], s21 offen offset:2048 nt lds
    ds_read_b32 v21, v22
    s_waitcnt vmcnt(16)
    buffer_load_dwordx4 v11, s[24:27], s21 offen offset:3072 nt lds
    s_and_b32 m0, s59, 0x1ffff
    s_waitcnt vmcnt(16)
    ds_add_u32 v5, v19
    buffer_load_dwordx4 v12, s[28:31], s58 offen nt lds
    v_readlane_b32 s21, v16, s42
    s_waitcnt vmcnt(16)
    buffer_load_dwordx4 v13, s[28:31], s58 offen offset:1024 nt lds
    s_add_u32 s59, s59, 0x2000
    s_waitcnt vmcnt(16)
    buffer_load_dwordx4 v14, s[28:31], s58 offen offset:2048 nt lds
    s_waitcnt vmcnt(16)
    buffer_load_dwordx4 v15, s[28:31], s58 offen offset:3072 nt lds
    v_readlane_b32 s58, v28, s42
    s_branch L_w68_top
L_w68_evt:
    s_cmp_eq_u32 s42, s44
    s_cbranch_scc1 L_rare
L_w68_slow:
    s_waitcnt lgkmcnt(0)
    v_readlane_b32 s60, v21, 0
    v_readlane_b32 s61, v21, 1
    v_readlane_b32 s62, v21, 2
    v_readlane_b32 s63, v21, 3
    ds_read_b32 v21, v22
    s_min_u32 s60, s60, s61
    s_min_u32 s62, s62, s63
    s_min_u32 s47, s60, s62
    s_add_u32 s47, s47, 16
    s_min_u32 s43, s44, s47
    s_cmp_lt_u32 s42, s47
    s_cbranch_scc1 L_w68_go
    s_branch L_w68_slow
L_w69:
    v_mov_b32 v6, s54
    v_add_u32 v6, -8, v6
    s_waitcnt vmcnt(20)
    ds_write_b32 v5, v6
    s_branch L_w69_evt
L_w69_top:
    s_cmp_ge_u32 s42, s43
    s_cbranch_scc1 L_w69_evt
L_w69_go:
    s_and_b32 m0, s48, 0x1ffff
    s_waitcnt vmcnt(16)
    ds_add_u32 v5, v19
    buffer_load_dwordx4 v8, s[24:27], s21 offen nt lds
    s_add_u32 s42, s42, 1
    s_waitcnt vmcnt(16)
    buffer_load_dwordx4 v9, s[24:27], s21 offen offset:1024 nt lds
    s_add_u32 s48, s48, 0x2000
    s_waitcnt vmcnt(16)
    buffer_load_dwordx4 v10, s[24:27], s21 offen offset:2048 nt lds
    ds_read_b32 v21, v22
    s_waitcnt vmcnt(17)
    buffer_load_dwordx4 v11, s[24:27], s21 offen offset:3072 nt lds
    s_and_b32 m0, s59, 0x1ffff
    s_waitcnt vmcnt(16)
    ds_add_u32 v5, v19
    buffer_load_dwordx4 v12, s[28:31], s58 offen nt lds
    v_readlane_b32 s21, v16, s42
    s_waitcnt vmcnt(16)
    buffer_load_dwordx4 v13, s[28:31], s58 offen offset:1024 nt lds
    s_add_u32 s59, s59, 0x2000
    s_waitcnt vmcnt(16)
    buffer_load_dwordx4 v14, s[28:31], s58 offen offset:2048 nt lds
    s_waitcnt vmcnt(17)
    buffer_load_dwordx4 v15, s[28:31], s58 offen offset:3072 nt lds
    v_readlane_b32 s58, v28, s42
    s_branch L_w69_top
L_w69_evt:
    s_cmp_eq_u32 s42, s44
    s_cbranch_scc1 L_rare
L_w69_slow:
    s_waitcnt lgkmcnt(0)
    v_readlane_b32 s60, v21, 0
    v_readlane_b32 s61, v21, 1
    v_readlane_b32 s62, v21, 2
    v_readlane_b32 s63, v21, 3
    ds_read_b32 v21, v22
    s_min_u32 s60, s60, s61
    s_min_u32 s62, s62, s63
    s_min_u32 s47, s60, s62
    s_add_u32 s47, s47, 16
    s_min_u32 s43, s44, s47
    s_cmp_lt_u32 s42, s47
    s_cbranch_scc1 L_w69_go
    s_branch L_w69_slow
L_w70:
    v_mov_b32 v6, s54
    v_add_u32 v6, -8, v6
    s_waitcnt vmcnt(20)
    ds_write_b32 v5, v6
    s_branch L_w70_evt
L_w70_top:
    s_cmp_ge_u32 s42, s43
    s_cbranch_scc1 L_w70_evt
L_w70_go:
    s_and_b32 m0, s48, 0x1ffff
    s_waitcnt vmcnt(16)
    ds_add_u32 v5, v19
    buffer_load_dwordx4 v8, s[24:27], s21 offen nt lds
    s_add_u32 s42, s42, 1
    s_waitcnt vmcnt(17)
    buffer_load_dwordx4 v9, s[24:27], s21 offen offset:1024 nt lds
    s_add_u32 s48, s48, 0x2000
    s_waitcnt vmcnt(16)
    buffer_load_dwordx4 v10, s[24:27], s21 offen offset:2048 nt lds
    ds_read_b32 v21, v22
    s_waitcnt vmcnt(17)
    buffer_load_dwordx4 v11, s[24:27], s21 offen offset:3072 nt lds
    s_and_b32 m0, s59, 0x1ffff
    s_waitcnt vmcnt(16)
    ds_add_u32 v5, v19
    buffer_load_dwordx4 v12, s[28:31], s58 offen nt lds
    v_readlane_b32 s21, v16, s42
    s_waitcnt vmcnt(17)
    buffer_load_dwordx4 v13, s[28:31], s58 offen offset:1024 nt lds
    s_add_u32 s59, s59, 0x2000
    s_waitcnt vmcnt(16)
    buffer_load_dwordx4 v14, s[28:31], s58 offen offset:2048 nt lds
    s_waitcnt vmcnt(17)
    buffer_load_dwordx4 v15, s[28:31], s58 offen offset:3072 nt lds
    v_readlane_b32 s58, v28, s42
    s_branch L_w70_top
L_w70_evt:
    s_cmp_eq_u32 s42, s44
    s_cbranch_scc1 L_rare
L_w70_slow:
    s_waitcnt lgkmcnt(0)
    v_readlane_b32 s60, v21, 0
    v_readlane_b32 s61, v21, 1
    v_readlane_b32 s62, v21, 2
    v_readlane_b32 s63, v21, 3
    ds_read_b32 v21, v22
    s_min_u32 s60, s60, s61
    s_min_u32 s62, s62, s63
    s_min_u32 s47, s60, s62
    s_add_u32 s47, s47, 16
    s_min_u32 s43, s44, s47
    s_cmp_lt_u32 s42, s47
    s_cbranch_scc1 L_w70_go
    s_branch L_w70_slow
L_w71:
    v_mov_b32 v6, s54
    v_add_u32 v6, -8, v6
    s_waitcnt vmcnt(20)
    ds_write_b32 v5, v6
    s_branch L_w71_evt
L_w71_top:
    s_cmp_ge_u32 s42, s43
    s_cbranch_scc1 L_w71_evt
L_w71_go:
    s_and_b32 m0, s48, 0x1ffff
    s_waitcnt vmcnt(16)
    ds_add_u32 v5, v19
    buffer_load_dwordx4 v8, s[24:27], s21 offen nt lds
    s_add_u32 s42, s42, 1
    s_waitcnt vmcnt(17)
    buffer_load_dwordx4 v9, s[24:27], s21 offen offset:1024 nt lds
    s_add_u32 s48, s48, 0x2000
    s_waitcnt vmcnt(17)
    buffer_load_dwordx4 v10, s[24:27], s21 offen offset:2048 nt lds
    ds_read_b32 v21, v22
    s_waitcnt vmcnt(17)
    buffer_load_dwordx4 v11, s[24:27], s21 offen offset:3072 nt lds
    s_and_b32 m0, s59, 0x1ffff
    s_waitcnt vmcnt(16)
    ds_add_u32 v5, v19
    buffer_load_dwordx4 v12, s[28:31], s58 offen nt lds
    v_readlane_b32 s21, v16, s42
    s_waitcnt vmcnt(17)
    buffer_load_dwordx4 v13, s[28:31], s58 offen offset:1024 nt lds
    s_add_u32 s59, s59, 0x2000
    s_waitcnt vmcnt(17)
    buffer_load_dwordx4 v14, s[28:31], s58 offen offset:2048 nt lds
    s_waitcnt vmcnt(17)
    buffer_load_dwordx4 v15, s[28:31], s58 offen offset:3072 nt lds
    v_readlane_b32 s58, v28, s42
    s_branch L_w71_top
L_w71_evt:
    s_cmp_eq_u32 s42, s44
    s_cbranch_scc1 L_rare
L_w71_slow:
    s_waitcnt lgkmcnt(0)
    v_readlane_b32 s60, v21, 0
    v_readlane_b32 s61, v21, 1
    v_readlane_b32 s62, v21, 2
    v_readlane_b32 s63, v21, 3
    ds_read_b32 v21, v22
    s_min_u32 s60, s60, s61
    s_min_u32 s62, s62, s63
    s_min_u32 s47, s60, s62
    s_add_u32 s47, s47, 16
    s_min_u32 s43, s44, s47
    s_cmp_lt_u32 s42, s47
    s_cbranch_scc1 L_w71_go
    s_branch L_w71_slow
L_w72:
    v_mov_b32 v6, s54
    v_add_u32 v6, -8, v6
    s_waitcnt vmcnt(20)
    ds_write_b32 v5, v6
    s_branch L_w72_evt
L_w72_top:
    s_cmp_ge_u32 s42, s43
    s_cbranch_scc1 L_w72_evt
L_w72_go:
    s_and_b32 m0, s48, 0x1ffff
    s_waitcnt vmcnt(17)
    buffer_load_dwordx4 v8, s[24:27], s21 offen nt lds
    s_add_u32 s42, s42, 1
    s_waitcnt vmcnt(17)
    ds_add_u32 v5, v19
    buffer_load_dwordx4 v9, s[24:27], s21 offen offset:1024 nt lds
    s_add_u32 s48, s48, 0x2000
    s_waitcnt vmcnt(17)
    buffer_load_dwordx4 v10, s[24:27], s21 offen offset:2048 nt lds
    ds_read_b32 v21, v22
    s_waitcnt vmcnt(17)
    buffer_load_dwordx4 v11, s[24:27], s21 offen offset:3072 nt lds
    s_and_b32 m0, s59, 0x1ffff
    s_waitcnt vmcnt(17)
    buffer_load_dwordx4 v12, s[28:31], s58 offen nt lds
    v_readlane_b32 s21, v16, s42
    s_waitcnt vmcnt(17)
    ds_add_u32 v5, v19
    buffer_load_dwordx4 v13, s[28:31], s58 offen offset:1024 nt lds
    s_add_u32 s59, s59, 0x2000
    s_waitcnt vmcnt(17)
    buffer_load_dwordx4 v14, s[28:31], s58 offen offset:2048 nt lds
    s_waitcnt vmcnt(17)
    buffer_load_dwordx4 v15, s[28:31], s58 offen offset:3072 nt lds
    v_readlane_b32 s58, v28, s42
    s_branch L_w72_top
L_w72_evt:
    s_cmp_eq_u32 s42, s44
    s_cbranch_scc1 L_rare
L_w72_slow:
    s_waitcnt lgkmcnt(0)
    v_readlane_b32 s60, v21, 0
    v_readlane_b32 s61, v21, 1
    v_readlane_b32 s62, v21, 2
    v_readlane_b32 s63, v21, 3
    ds_read_b32 v21, v22
    s_min_u32 s60, s60, s61
    s_min_u32 s62, s62, s63
    s_min_u32 s47, s60, s62
    s_add_u32 s47, s47, 16
    s_min_u32 s43, s44, s47
    s_cmp_lt_u32 s42, s47
    s_cbranch_scc1 L_w72_go
    s_branch L_w72_slow
L_w73:
    v_mov_b32 v6, s54
    v_add_u32 v6, -8, v6
    s_waitcnt vmcnt(20)
    ds_write_b32 v5, v6
    s_branch L_w73_evt
L_w73_top:
    s_cmp_ge_u32 s42, s43
    s_cbranch_scc1 L_w73_evt
L_w73_go:
    s_and_b32 m0, s48, 0x1ffff
    s_waitcnt vmcnt(17)
    buffer_load_dwordx4 v8, s[24:27], s21 offen nt lds
    s_add_u32 s42, s42, 1
    s_waitcnt vmcnt(17)
    ds_add_u32 v5, v19
    buffer_load_dwordx4 v9, s[24:27], s21 offen offset:1024 nt lds
    s_add_u32 s48, s48, 0x2000
    s_waitcnt vmcnt(17)
    buffer_load_dwordx4 v10, s[24:27], s21 offen offset:2048 nt lds
    ds_read_b32 v21, v22
    s_waitcnt vmcnt(18)
    buffer_load_dwordx4 v11, s[24:27], s21 offen offset:3072 nt lds
    s_and_b32 m0, s59, 0x1ffff
    s_waitcnt vmcnt(17)
    buffer_load_dwordx4 v12, s[28:31], s58 offen nt lds
    v_readlane_b32 s21, v16, s42
    s_waitcnt vmcnt(17)
    ds_add_u32 v5, v19
    buffer_load_dwordx4 v13, s[28:31], s58 offen offset:1024 nt lds
    s_add_u32 s59, s59, 0x2000
    s_waitcnt vmcnt(17)
    buffer_load_dwordx4 v14, s[28:31], s58 offen offset:2048 nt lds
    s_waitcnt vmcnt(18)
    buffer_load_dwordx4 v15, s[28:31], s58 offen offset:3072 nt lds
    v_readlane_b32 s58, v28, s42
    s_branch L_w73_top
L_w73_evt:
    s_cmp_eq_u32 s42, s44
    s_cbranch_scc1 L_rare
L_w73_slow:
    s_waitcnt lgkmcnt(0)
    v_readlane_b32 s60, v21, 0
    v_readlane_b32 s61, v21, 1
    v_readlane_b32 s62, v21, 2
    v_readlane_b32 s63, v21, 3
    ds_read_b32 v21, v22
    s_min_u32 s60, s60, s61
    s_min_u32 s62, s62, s63
    s_min_u32 s47, s60, s62
    s_add_u32 s47, s47, 16
    s_min_u32 s43, s44, s47
    s_cmp_lt_u32 s42, s47
    s_cbranch_scc1 L_w73_go
    s_branch L_w73_slow
L_w74:
    v_mov_b32 v6, s54
    v_add_u32 v6, -8, v6
    s_waitcnt vmcnt(20)
    ds_write_b32 v5, v6
    s_branch L_w74_evt
L_w74_top:
    s_cmp_ge_u32 s42, s43
    s_cbranch_scc1 L_w74_evt
L_w74_go:
    s_and_b32 m0, s48, 0x1ffff
    s_waitcnt vmcnt(17)
    buffer_load_dwordx4 v8, s[24:27], s21 offen nt lds
    s_add_u32 s42, s42, 1
    s_waitcnt vmcnt(18)
    buffer_load_dwordx4 v9, s[24:27], s21 offen offset:1024 nt lds
    s_add_u32 s48, s48, 0x2000
    s_waitcnt vmcnt(17)
    ds_add_u32 v5, v19
    buffer_load_dwordx4 v10, s[24:27], s21 offen offset:2048 nt lds
    ds_read_b32 v21, v22
    s_waitcnt vmcnt(18)
    buffer_load_dwordx4 v11, s[24:27], s21 offen offset:3072 nt lds
    s_and_b32 m0, s59, 0x1ffff
    s_waitcnt vmcnt(17)
    buffer_load_dwordx4 v12, s[28:31], s58 offen nt lds
    v_readlane_b32 s21, v16, s42
    s_waitcnt vmcnt(18)
    buffer_load_dwordx4 v13, s[28:31], s58 offen offset:1024 nt lds
    s_add_u32 s59, s59, 0x2000
    s_waitcnt vmcnt(17)
    ds_add_u32 v5, v19
    buffer_load_dwordx4 v14, s[28:31], s58 offen offset:2048 nt lds
    s_waitcnt vmcnt(18)
    buffer_load_dwordx4 v15, s[28:31], s58 offen offset:3072 nt lds
    v_readlane_b32 s58, v28, s42
    s_branch L_w74_top
L_w74_evt:
    s_cmp_eq_u32 s42, s44
    s_cbranch_scc1 L_rare
L_w74_slow:
    s_waitcnt lgkmcnt(0)
    v_readlane_b32 s60, v21, 0
    v_readlane_b32 s61, v21, 1
    v_readlane_b32 s62, v21, 2
    v_readlane_b32 s63, v21, 3
    ds_read_b32 v21, v22
    s_min_u32 s60, s60, s61
    s_min_u32 s62, s62, s63
    s_min_u32 s47, s60, s62
    s_add_u32 s47, s47, 16
    s_min_u32 s43, s44, s47
    s_cmp_lt_u32 s42, s47
    s_cbranch_scc1 L_w74_go
    s_branch L_w74_slow
L_w75:
    v_mov_b32 v6, s54
    v_add_u32 v6, -8, v6
    s_waitcnt vmcnt(20)
    ds_write_b32 v5, v6
    s_branch L_w75_evt
L_w75_top:
    s_cmp_ge_u32 s42, s43
    s_cbranch_scc1 L_w75_evt
L_w75_go:
    s_and_b32 m0, s48, 0x1ffff
    s_waitcnt vmcnt(17)
    buffer_load_dwordx4 v8, s[24:27], s21 offen nt lds
    s_add_u32 s42, s42, 1
    s_waitcnt vmcnt(18)
    buffer_load_dwordx4 v9, s[24:27], s21 offen offset:1024 nt lds
    s_add_u32 s48, s48, 0x2000
    s_waitcnt vmcnt(18)
    ds_add_u32 v5, v19
    buffer_load_dwordx4 v10, s[24:27], s21 offen offset:2048 nt lds
    ds_read_b32 v21, v22
    s_waitcnt vmcnt(18)
    buffer_load_dwordx4 v11, s[24:27], s21 offen offset:3072 nt lds
    s_and_b32 m0, s59, 0x1ffff
    s_waitcnt vmcnt(17)
    buffer_load_dwordx4 v12, s[28:31], s58 offen nt lds
    v_readlane_b32 s21, v16, s42
    s_waitcnt vmcnt(18)
    buffer_load_dwordx4 v13, s[28:31], s58 offen offset:1024 nt lds
    s_add_u32 s59, s59, 0x2000
    s_waitcnt vmcnt(18)
    ds_add_u32 v5, v19
    buffer_load_dwordx4 v14, s[28:31], s58 offen offset:2048 nt lds
    s_waitcnt vmcnt(18)
    buffer_load_dwordx4 v15, s[28:31], s58 offen offset:3072 nt lds
    v_readlane_b32 s58, v28, s42
    s_branch L_w75_top
L_w75_evt:
    s_cmp_eq_u32 s42, s44
    s_cbranch_scc1 L_rare
L_w75_slow:
    s_waitcnt lgkmcnt(0)
    v_readlane_b32 s60, v21, 0
    v_readlane_b32 s61, v21, 1
    v_readlane_b32 s62, v21, 2
    v_readlane_b32 s63, v21, 3
    ds_read_b32 v21, v22
    s_min_u32 s60, s60, s61
    s_min_u32 s62, s62, s63
    s_min_u32 s47, s60, s62
    s_add_u32 s47, s47, 16
    s_min_u32 s43, s44, s47
    s_cmp_lt_u32 s42, s47
    s_cbranch_scc1 L_w75_go
    s_branch L_w75_slow
L_w76:
    v_mov_b32 v6, s54
    v_add_u32 v6, -8, v6
    s_waitcnt vmcnt(20)
    ds_write_b32 v5, v6
    s_branch L_w76_evt
L_w76_top:
    s_cmp_ge_u32 s42, s43
    s_cbranch_scc1 L_w76_evt
L_w76_go:
    s_and_b32 m0, s48, 0x1ffff
    s_waitcnt vmcnt(18)
    buffer_load_dwordx4 v8, s[24:27], s21 offen nt lds
    s_add_u32 s42, s42, 1
    s_waitcnt vmcnt(18)
    buffer_load_dwordx4 v9, s[24:27], s21 offen offset:1024 nt lds
    s_add_u32 s48, s48, 0x2000
    s_waitcnt vmcnt(18)
    ds_add_u32 v5, v19
    buffer_load_dwordx4 v10, s[24:27], s21 offen offset:2048 nt lds
    ds_read_b32 v21, v22
    s_waitcnt vmcnt(18)
    buffer_load_dwordx4 v11, s[24:27], s21 offen offset:3072 nt lds
    s_and_b32 m0, s59, 0x1ffff
    s_waitcnt vmcnt(18)
    buffer_load_dwordx4 v12, s[28:31], s58 offen nt lds
    v_readlane_b32 s21, v16, s42
    s_waitcnt vmcnt(18)
    buffer_load_dwordx4 v13, s[28:31], s58 offen offset:1024 nt lds
    s_add_u32 s59, s59, 0x2000
    s_waitcnt vmcnt(18)
    ds_add_u32 v5, v19
    buffer_load_dwordx4 v14, s[28:31], s58 offen offset:2048 nt lds
    s_waitcnt vmcnt(18)
    buffer_load_dwordx4 v15, s[28:31], s58 offen offset:3072 nt lds
    v_readlane_b32 s58, v28, s42
    s_branch L_w76_top
L_w76_evt:
    s_cmp_eq_u32 s42, s44
    s_cbranch_scc1 L_rare
L_w76_slow:
    s_waitcnt lgkmcnt(0)
    v_readlane_b32 s60, v21, 0
    v_readlane_b32 s61, v21, 1
    v_readlane_b32 s62, v21, 2
    v_readlane_b32 s63, v21, 3
    ds_read_b32 v21, v22
    s_min_u32 s60, s60, s61
    s_min_u32 s62, s62, s63
    s_min_u32 s47, s60, s62
    s_add_u32 s47, s47, 16
    s_min_u32 s43, s44, s47
    s_cmp_lt_u32 s42, s47
    s_cbranch_scc1 L_w76_go
    s_branch L_w76_slow
L_w77:
    v_mov_b32 v6, s54
    v_add_u32 v6, -8, v6
    s_waitcnt vmcnt(20)
    ds_write_b32 v5, v6
    s_branch L_w77_evt
L_w77_top:
    s_cmp_ge_u32 s42, s43
    s_cbranch_scc1 L_w77_evt
L_w77_go:
    s_and_b32 m0, s48, 0x1ffff
    s_waitcnt vmcnt(18)
    buffer_load_dwordx4 v8, s[24:27], s21 offen nt lds
    s_add_u32 s42, s42, 1
    s_waitcnt vmcnt(18)
    buffer_load_dwordx4 v9, s[24:27], s21 offen offset:1024 nt lds
    s_add_u32 s48, s48, 0x2000
    s_waitcnt vmcnt(18)
    ds_add_u32 v5, v19
    buffer_load_dwordx4 v10, s[24:27], s21 offen offset:2048 nt lds
    ds_read_b32 v21, v22
    s_waitcnt vmcnt(19)
    buffer_load_dwordx4 v11, s[24:27], s21 offen offset:3072 nt lds
    s_and_b32 m0, s59, 0x1ffff
    s_waitcnt vmcnt(18)
    buffer_load_dwordx4 v12, s[28:31], s58 offen nt lds
    v_readlane_b32 s21, v16, s42
    s_waitcnt vmcnt(18)
    buffer_load_dwordx4 v13, s[28:31], s58 offen offset:1024 nt lds
    s_add_u32 s59, s59, 0x2000
    s_waitcnt vmcnt(18)
    ds_add_u32 v5, v19
    buffer_load_dwordx4 v14, s[28:31], s58 offen offset:2048 nt lds
    s_waitcnt vmcnt(19)
    buffer_load_dwordx4 v15, s[28:31], s58 offen offset:3072 nt lds
    v_readlane_b32 s58, v28, s42
    s_branch L_w77_top
L_w77_evt:
    s_cmp_eq_u32 s42, s44
    s_cbranch_scc1 L_rare
L_w77_slow:
    s_waitcnt lgkmcnt(0)
    v_readlane_b32 s60, v21, 0
    v_readlane_b32 s61, v21, 1
    v_readlane_b32 s62, v21, 2
    v_readlane_b32 s63, v21, 3
    ds_read_b32 v21, v22
    s_min_u32 s60, s60, s61
    s_min_u32 s62, s62, s63
    s_min_u32 s47, s60, s62
    s_add_u32 s47, s47, 16
    s_min_u32 s43, s44, s47
    s_cmp_lt_u32 s42, s47
    s_cbranch_scc1 L_w77_go
    s_branch L_w77_slow
L_w78:
    v_mov_b32 v6, s54
    v_add_u32 v6, -8, v6
    s_waitcnt vmcnt(20)
    ds_write_b32 v5, v6
    s_branch L_w78_evt
L_w78_top:
    s_cmp_ge_u32 s42, s43
    s_cbranch_scc1 L_w78_evt
L_w78_go:
    s_and_b32 m0, s48, 0x1ffff
    s_waitcnt vmcnt(18)
    buffer_load_dwordx4 v8, s[24:27], s21 offen nt lds
    s_add_u32 s42, s42, 1
    s_waitcnt vmcnt(19)
    buffer_load_dwordx4 v9, s[24:27], s21 offen offset:1024 nt lds
    s_add_u32 s48, s48, 0x2000
    s_waitcnt vmcnt(18)
    ds_add_u32 v5, v19
    buffer_load_dwordx4 v10, s[24:27], s21 offen offset:2048 nt lds
    ds_read_b32 v21, v22
    s_waitcnt vmcnt(19)
    buffer_load_dwordx4 v11, s[24:27], s21 offen offset:3072 nt lds
    s_and_b32 m0, s59, 0x1ffff
    s_waitcnt vmcnt(18)
    buffer_load_dwordx4 v12, s[28:31], s58 offen nt lds
    v_readlane_b32 s21, v16, s42
    s_waitcnt vmcnt(19)
    buffer_load_dwordx4 v13, s[28:31], s58 offen offset:1024 nt lds
    s_add_u32 s59, s59, 0x2000
    s_waitcnt vmcnt(18)
    ds_add_u32 v5, v19
    buffer_load_dwordx4 v14, s[28:31], s58 offen offset:2048 nt lds
    s_waitcnt vmcnt(19)
    buffer_load_dwordx4 v15, s[28:31], s58 offen offset:3072 nt lds
    v_readlane_b32 s58, v28, s42
    s_branch L_w78_top
L_w78_evt:
    s_cmp_eq_u32 s42, s44
    s_cbranch_scc1 L_rare
L_w78_slow:
    s_waitcnt lgkmcnt(0)
    v_readlane_b32 s60, v21, 0
    v_readlane_b32 s61, v21, 1
    v_readlane_b32 s62, v21, 2
    v_readlane_b32 s63, v21, 3
    ds_read_b32 v21, v22
    s_min_u32 s60, s60, s61
    s_min_u32 s62, s62, s63
    s_min_u32 s47, s60, s62
    s_add_u32 s47, s47, 16
    s_min_u32 s43, s44, s47
    s_cmp_lt_u32 s42, s47
    s_cbranch_scc1 L_w78_go
    s_branch L_w78_slow
L_w79:
    v_mov_b32 v6, s54
    v_add_u32 v6, -8, v6
    s_waitcnt vmcnt(20)
    ds_write_b32 v5, v6
    s_branch L_w79_evt
L_w79_top:
    s_cmp_ge_u32 s42, s43
    s_cbranch_scc1 L_w79_evt
L_w79_go:
    s_and_b32 m0, s48, 0x1ffff
    s_waitcnt vmcnt(18)
    buffer_load_dwordx4 v8, s[24:27], s21 offen nt lds
    s_add_u32 s42, s42, 1
    s_waitcnt vmcnt(19)
    buffer_load_dwordx4 v9, s[24:27], s21 offen offset:1024 nt lds
    s_add_u32 s48, s48, 0x2000
    s_waitcnt vmcnt(19)
    buffer_load_dwordx4 v10, s[24:27], s21 offen offset:2048 nt lds
    ds_read_b32 v21, v22
    s_waitcnt vmcnt(19)
    ds_add_u32 v5, v19
    buffer_load_dwordx4 v11, s[24:27], s21 offen offset:3072 nt lds
    s_and_b32 m0, s59, 0x1ffff
    s_waitcnt vmcnt(18)
    buffer_load_dwordx4 v12, s[28:31], s58 offen nt lds
    v_readlane_b32 s21, v16, s42
    s_waitcnt vmcnt(19)
    buffer_load_dwordx4 v13, s[28:31], s58 offen offset:1024 nt lds
    s_add_u32 s59, s59, 0x2000
    s_waitcnt vmcnt(19)
    buffer_load_dwordx4 v14, s[28:31], s58 offen offset:2048 nt lds
    s_waitcnt vmcnt(19)
    ds_add_u32 v5, v19
    buffer_load_dwordx4 v15, s[28:31], s58 offen offset:3072 nt lds
    v_readlane_b32 s58, v28, s42
    s_branch L_w79_top
L_w79_evt:
    s_cmp_eq_u32 s42, s44
    s_cbranch_scc1 L_rare
L_w79_slow:
    s_waitcnt lgkmcnt(0)
    v_readlane_b32 s60, v21, 0
    v_readlane_b32 s61, v21, 1
    v_readlane_b32 s62, v21, 2
    v_readlane_b32 s63, v21, 3
    ds_read_b32 v21, v22
    s_min_u32 s60, s60, s61
    s_min_u32 s62, s62, s63
    s_min_u32 s47, s60, s62
    s_add_u32 s47, s47, 16
    s_min_u32 s43, s44, s47
    s_cmp_lt_u32 s42, s47
    s_cbranch_scc1 L_w79_go
    s_branch L_w79_slow
L_w80:
    v_mov_b32 v6, s54
    v_add_u32 v6, -8, v6
    s_waitcnt vmcnt(20)
    ds_write_b32 v5, v6
    s_branch L_w80_evt
L_w80_top:
    s_cmp_ge_u32 s42, s43
    s_cbranch_scc1 L_w80_evt
L_w80_go:
    s_and_b32 m0, s48, 0x1ffff
    s_waitcnt vmcnt(19)
    buffer_load_dwordx4 v8, s[24:27], s21 offen nt lds
    s_add_u32 s42, s42, 1
    s_waitcnt vmcnt(19)
    buffer_load_dwordx4 v9, s[24:27], s21 offen offset:1024 nt lds
    s_add_u32 s48, s48, 0x2000
    s_waitcnt vmcnt(19)
    buffer_load_dwordx4 v10, s[24:27], s21 offen offset:2048 nt lds
    ds_read_b32 v21, v22
    s_waitcnt vmcnt(19)
    ds_add_u32 v5, v19
    buffer_load_dwordx4 v11, s[24:27], s21 offen offset:3072 nt lds
    s_and_b32 m0, s59, 0x1ffff
    s_waitcnt vmcnt(19)
    buffer_load_dwordx4 v12, s[28:31], s58 offen nt lds
    v_readlane_b32 s21, v16, s42
    s_waitcnt vmcnt(19)
    buffer_load_dwordx4 v13, s[28:31], s58 offen offset:1024 nt lds
    s_add_u32 s59, s59, 0x2000
    s_waitcnt vmcnt(19)
    buffer_load_dwordx4 v14, s[28:31], s58 offen offset:2048 nt lds
    s_waitcnt vmcnt(19)
    ds_add_u32 v5, v19
    buffer_load_dwordx4 v15, s[28:31], s58 offen offset:3072 nt lds
    v_readlane_b32 s58, v28, s42
    s_branch L_w80_top
L_w80_evt:
    s_cmp_eq_u32 s42, s44
    s_cbranch_scc1 L_rare
L_w80_slow:
    s_waitcnt lgkmcnt(0)
    v_readlane_b32 s60, v21, 0
    v_readlane_b32 s61, v21, 1
    v_readlane_b32 s62, v21, 2
    v_readlane_b32 s63, v21, 3
    ds_read_b32 v21, v22
    s_min_u32 s60, s60, s61
    s_min_u32 s62, s62, s63
    s_min_u32 s47, s60, s62
    s_add_u32 s47, s47, 16
    s_min_u32 s43, s44, s47
    s_cmp_lt_u32 s42, s47
    s_cbranch_scc1 L_w80_go
    s_branch L_w80_slow
L_w81:
    v_mov_b32 v6, s54
    v_add_u32 v6, -9, v6
    s_waitcnt vmcnt(24)
    ds_write_b32 v5, v6
    s_branch L_w81_evt
L_w81_top:
    s_cmp_ge_u32 s42, s43
    s_cbranch_scc1 L_w81_evt
L_w81_go:
    s_and_b32 m0, s48, 0x1ffff
    s_waitcnt vmcnt(19)
    ds_add_u32 v5, v19
    buffer_load_dwordx4 v8, s[24:27], s21 offen nt lds
    s_add_u32 s42, s42, 1
    s_waitcnt vmcnt(19)
    buffer_load_dwordx4 v9, s[24:27], s21 offen offset:1024 nt lds
    s_add_u32 s48, s48, 0x2000
    s_waitcnt vmcnt(19)
    buffer_load_dwordx4 v10, s[24:27], s21 offen offset:2048 nt lds
    ds_read_b32 v21, v22
    s_waitcnt vmcnt(20)
    buffer_load_dwordx4 v11, s[24:27], s21 offen offset:3072 nt lds
    s_and_b32 m0, s59, 0x1ffff
    s_waitcnt vmcnt(19)
    ds_add_u32 v5, v19
    buffer_load_dwordx4 v12, s[28:31], s58 offen nt lds
    v_readlane_b32 s21, v16, s42
    s_waitcnt vmcnt(19)
    buffer_load_dwordx4 v13, s[28:31], s58 offen offset:1024 nt lds
    s_add_u32 s59, s59, 0x2000
    s_waitcnt vmcnt(19)
    buffer_load_dwordx4 v14, s[28:31], s58 offen offset:2048 nt lds
    s_waitcnt vmcnt(20)
    buffer_load_dwordx4 v15, s[28:31], s58 offen offset:3072 nt lds
    v_readlane_b32 s58, v28, s42
    s_branch L_w81_top
L_w81_evt:
    s_cmp_eq_u32 s42, s44
    s_cbranch_scc1 L_rare
L_w81_slow:
    s_waitcnt lgkmcnt(0)
    v_readlane_b32 s60, v21, 0
    v_readlane_b32 s61, v21, 1
    v_readlane_b32 s62, v21, 2
    v_readlane_b32 s63, v21, 3
    ds_read_b32 v21, v22
    s_min_u32 s60, s60, s61
    s_min_u32 s62, s62, s63
    s_min_u32 s47, s60, s62
    s_add_u32 s47, s47, 16
    s_min_u32 s43, s44, s47
    s_cmp_lt_u32 s42, s47
    s_cbranch_scc1 L_w81_go
    s_branch L_w81_slow
L_w82:
    v_mov_b32 v6, s54
    v_add_u32 v6, -9, v6
    s_waitcnt vmcnt(24)
    ds_write_b32 v5, v6
    s_branch L_w82_evt
L_w82_top:
    s_cmp_ge_u32 s42, s43
    s_cbranch_scc1 L_w82_evt
L_w82_go:
    s_and_b32 m0, s48, 0x1ffff
    s_waitcnt vmcnt(19)
    ds_add_u32 v5, v19
    buffer_load_dwordx4 v8, s[24:27], s21 offen nt lds
    s_add_u32 s42, s42, 1
    s_waitcnt vmcnt(20)
    buffer_load_dwordx4 v9, s[24:27], s21 offen offset:1024 nt lds
    s_add_u32 s48, s48, 0x2000
    s_waitcnt vmcnt(19)
    buffer_load_dwordx4 v10, s[24:27], s21 offen offset:2048 nt lds
    ds_read_b32 v21, v22
    s_waitcnt vmcnt(20)
    buffer_load_dwordx4 v11, s[24:27], s21 offen offset:3072 nt lds
    s_and_b32 m0, s59, 0x1ffff
    s_waitcnt vmcnt(19)
    ds_add_u32 v5, v19
    buffer_load_dwordx4 v12, s[28:31], s58 offen nt lds
    v_readlane_b32 s21, v16, s42
    s_waitcnt vmcnt(20)
    buffer_load_dwordx4 v13, s[28:31], s58 offen offset:1024 nt lds
    s_add_u32 s59, s59, 0x2000
    s_waitcnt vmcnt(19)
    buffer_load_dwordx4 v14, s[28:31], s58 offen offset:2048 nt lds
    s_waitcnt vmcnt(20)
    buffer_load_dwordx4 v15, s[28:31], s58 offen offset:3072 nt lds
    v_readlane_b32 s58, v28, s42
    s_branch L_w82_top
L_w82_evt:
    s_cmp_eq_u32 s42, s44
    s_cbranch_scc1 L_rare
L_w82_slow:
    s_waitcnt lgkmcnt(0)
    v_readlane_b32 s60, v21, 0
    v_readlane_b32 s61, v21, 1
    v_readlane_b32 s62, v21, 2
    v_readlane_b32 s63, v21, 3
    ds_read_b32 v21, v22
    s_min_u32 s60, s60, s61
    s_min_u32 s62, s62, s63
    s_min_u32 s47, s60, s62
    s_add_u32 s47, s47, 16
    s_min_u32 s43, s44, s47
    s_cmp_lt_u32 s42, s47
    s_cbranch_scc1 L_w82_go
    s_branch L_w82_slow
L_w83:
    v_mov_b32 v6, s54
    v_add_u32 v6, -9, v6
    s_waitcnt vmcnt(24)
    ds_write_b32 v5, v6
    s_branch L_w83_evt
L_w83_top:
    s_cmp_ge_u32 s42, s43
    s_cbranch_scc1 L_w83_evt
L_w83_go:
    s_and_b32 m0, s48, 0x1ffff
    s_waitcnt vmcnt(19)
    ds_add_u32 v5, v19
    buffer_load_dwordx4 v8, s[24:27], s21 offen nt lds
    s_add_u32 s42, s42, 1
    s_waitcnt vmcnt(20)
    buffer_load_dwordx4 v9, s[24:27], s21 offen offset:1024 nt lds
    s_add_u32 s48, s48, 0x2000
    s_waitcnt vmcnt(20)
    buffer_load_dwordx4 v10, s[24:27], s21 offen offset:2048 nt lds
    ds_read_b32 v21, v22
    s_waitcnt vmcnt(20)
    buffer_load_dwordx4 v11, s[24:27], s21 offen offset:3072 nt lds
    s_and_b32 m0, s59, 0x1ffff
    s_waitcnt vmcnt(19)
    ds_add_u32 v5, v19
    buffer_load_dwordx4 v12, s[28:31], s58 offen nt lds
    v_readlane_b32 s21, v16, s42
    s_waitcnt vmcnt(20)
    buffer_load_dwordx4 v13, s[28:31], s58 offen offset:1024 nt lds
    s_add_u32 s59, s59, 0x2000
    s_waitcnt vmcnt(20)
    buffer_load_dwordx4 v14, s[28:31], s58 offen offset:2048 nt lds
    s_waitcnt vmcnt(20)
    buffer_load_dwordx4 v15, s[28:31], s58 offen offset:3072 nt lds
    v_readlane_b32 s58, v28, s42
    s_branch L_w83_top
L_w83_evt:
    s_cmp_eq_u32 s42, s44
    s_cbranch_scc1 L_rare
L_w83_slow:
    s_waitcnt lgkmcnt(0)
    v_readlane_b32 s60, v21, 0
    v_readlane_b32 s61, v21, 1
    v_readlane_b32 s62, v21, 2
    v_readlane_b32 s63, v21, 3
    ds_read_b32 v21, v22
    s_min_u32 s60, s60, s61
    s_min_u32 s62, s62, s63
    s_min_u32 s47, s60, s62
    s_add_u32 s47, s47, 16
    s_min_u32 s43, s44, s47
    s_cmp_lt_u32 s42, s47
    s_cbranch_scc1 L_w83_go
    s_branch L_w83_slow
L_w84:
    v_mov_b32 v6, s54
    v_add_u32 v6, -9, v6
    s_waitcnt vmcnt(24)
    ds_write_b32 v5, v6
    s_branch L_w84_evt
L_w84_top:
    s_cmp_ge_u32 s42, s43
    s_cbranch_scc1 L_w84_evt
L_w84_go:
    s_and_b32 m0, s48, 0x1ffff
    s_waitcnt vmcnt(20)
    ds_add_u32 v5, v19
    buffer_load_dwordx4 v8, s[24:27], s21 offen nt lds
    s_add_u32 s42, s42, 1
    s_waitcnt vmcnt(20)
    buffer_load_dwordx4 v9, s[24:27], s21 offen offset:1024 nt lds
    s_add_u32 s48, s48, 0x2000
    s_waitcnt vmcnt(20)
    buffer_load_dwordx4 v10, s[24:27], s21 offen offset:2048 nt lds
    ds_read_b32 v21, v22
    s_waitcnt vmcnt(20)
    buffer_load_dwordx4 v11, s[24:27], s21 offen offset:3072 nt lds
    s_and_b32 m0, s59, 0x1ffff
    s_waitcnt vmcnt(20)
    ds_add_u32 v5, v19
    buffer_load_dwordx4 v12, s[28:31], s58 offen nt lds
    v_readlane_b32 s21, v16, s42
    s_waitcnt vmcnt(20)
    buffer_load_dwordx4 v13, s[28:31], s58 offen offset:1024 nt lds
    s_add_u32 s59, s59, 0x2000
    s_waitcnt vmcnt(20)
    buffer_load_dwordx4 v14, s[28:31], s58 offen offset:2048 nt lds
    s_waitcnt vmcnt(20)
    buffer_load_dwordx4 v15, s[28:31], s58 offen offset:3072 nt lds
    v_readlane_b32 s58, v28, s42
    s_branch L_w84_top
L_w84_evt:
    s_cmp_eq_u32 s42, s44
    s_cbranch_scc1 L_rare
L_w84_slow:
    s_waitcnt lgkmcnt(0)
    v_readlane_b32 s60, v21, 0
    v_readlane_b32 s61, v21, 1
    v_readlane_b32 s62, v21, 2
    v_readlane_b32 s63, v21, 3
    ds_read_b32 v21, v22
    s_min_u32 s60, s60, s61
    s_min_u32 s62, s62, s63
    s_min_u32 s47, s60, s62
    s_add_u32 s47, s47, 16
    s_min_u32 s43, s44, s47
    s_cmp_lt_u32 s42, s47
    s_cbranch_scc1 L_w84_go
    s_branch L_w84_slow
L_w85:
    v_mov_b32 v6, s54
    v_add_u32 v6, -9, v6
    s_waitcnt vmcnt(24)
    ds_write_b32 v5, v6
    s_branch L_w85_evt
L_w85_top:
    s_cmp_ge_u32 s42, s43
    s_cbranch_scc1 L_w85_evt
L_w85_go:
    s_and_b32 m0, s48, 0x1ffff
    s_waitcnt vmcnt(20)
    ds_add_u32 v5, v19
    buffer_load_dwordx4 v8, s[24:27], s21 offen nt lds
    s_add_u32 s42, s42, 1
    s_waitcnt vmcnt(20)
    buffer_load_dwordx4 v9, s[24:27], s21 offen offset:1024 nt lds
    s_add_u32 s48, s48, 0x2000
    s_waitcnt vmcnt(20)
    buffer_load_dwordx4 v10, s[24:27], s21 offen offset:2048 nt lds
    ds_read_b32 v21, v22
    s_waitcnt vmcnt(21)
    buffer_load_dwordx4 v11, s[24:27], s21 offen offset:3072 nt lds
    s_and_b32 m0, s59, 0x1ffff
    s_waitcnt vmcnt(20)
    ds_add_u32 v5, v19
    buffer_load_dwordx4 v12, s[28:31], s58 offen nt lds
    v_readlane_b32 s21, v16, s42
    s_waitcnt vmcnt(20)
    buffer_load_dwordx4 v13, s[28:31], s58 offen offset:1024 nt lds
    s_add_u32 s59, s59, 0x2000
    s_waitcnt vmcnt(20)
    buffer_load_dwordx4 v14, s[28:31], s58 offen offset:2048 nt lds
    s_waitcnt vmcnt(21)
    buffer_load_dwordx4 v15, s[28:31], s58 offen offset:3072 nt lds
    v_readlane_b32 s58, v28, s42
    s_branch L_w85_top
L_w85_evt:
    s_cmp_eq_u32 s42, s44
    s_cbranch_scc1 L_rare
L_w85_slow:
    s_waitcnt lgkmcnt(0)
    v_readlane_b32 s60, v21, 0
    v_readlane_b32 s61, v21, 1
    v_readlane_b32 s62, v21, 2
    v_readlane_b32 s63, v21, 3
    ds_read_b32 v21, v22
    s_min_u32 s60, s60, s61
    s_min_u32 s62, s62, s63
    s_min_u32 s47, s60, s62
    s_add_u32 s47, s47, 16
    s_min_u32 s43, s44, s47
    s_cmp_lt_u32 s42, s47
    s_cbranch_scc1 L_w85_go
    s_branch L_w85_slow
L_w86:
    v_mov_b32 v6, s54
    v_add_u32 v6, -9, v6
    s_waitcnt vmcnt(24)
    ds_write_b32 v5, v6
    s_branch L_w86_evt
L_w86_top:
    s_cmp_ge_u32 s42, s43
    s_cbranch_scc1 L_w86_evt
L_w86_go:
    s_and_b32 m0, s48, 0x1ffff
    s_waitcnt vmcnt(20)
    ds_add_u32 v5, v19
    buffer_load_dwordx4 v8, s[24:27], s21 offen nt lds
    s_add_u32 s42, s42, 1
    s_waitcnt vmcnt(21)
    buffer_load_dwordx4 v9, s[24:27], s21 offen offset:1024 nt lds
    s_add_u32 s48, s48, 0x2000
    s_waitcnt vmcnt(20)
    buffer_load_dwordx4 v10, s[24:27], s21 offen offset:2048 nt lds
    ds_read_b32 v21, v22
    s_waitcnt vmcnt(21)
    buffer_load_dwordx4 v11, s[24:27], s21 offen offset:3072 nt lds
    s_and_b32 m0, s59, 0x1ffff
    s_waitcnt vmcnt(20)
    ds_add_u32 v5, v19
    buffer_load_dwordx4 v12, s[28:31], s58 offen nt lds
    v_readlane_b32 s21, v16, s42
    s_waitcnt vmcnt(21)
    buffer_load_dwordx4 v13, s[28:31], s58 offen offset:1024 nt lds
    s_add_u32 s59, s59, 0x2000
    s_waitcnt vmcnt(20)
    buffer_load_dwordx4 v14, s[28:31], s58 offen offset:2048 nt lds
    s_waitcnt vmcnt(21)
    buffer_load_dwordx4 v15, s[28:31], s58 offen offset:3072 nt lds
    v_readlane_b32 s58, v28, s42
    s_branch L_w86_top
L_w86_evt:
    s_cmp_eq_u32 s42, s44
    s_cbranch_scc1 L_rare
L_w86_slow:
    s_waitcnt lgkmcnt(0)
    v_readlane_b32 s60, v21, 0
    v_readlane_b32 s61, v21, 1
    v_readlane_b32 s62, v21, 2
    v_readlane_b32 s63, v21, 3
    ds_read_b32 v21, v22
    s_min_u32 s60, s60, s61
    s_min_u32 s62, s62, s63
    s_min_u32 s47, s60, s62
    s_add_u32 s47, s47, 16
    s_min_u32 s43, s44, s47
    s_cmp_lt_u32 s42, s47
    s_cbranch_scc1 L_w86_go
    s_branch L_w86_slow
L_w87:
    v_mov_b32 v6, s54
    v_add_u32 v6, -9, v6
    s_waitcnt vmcnt(24)
    ds_write_b32 v5, v6
    s_branch L_w87_evt
L_w87_top:
    s_cmp_ge_u32 s42, s43
    s_cbranch_scc1 L_w87_evt
L_w87_go:
    s_and_b32 m0, s48, 0x1ffff
    s_waitcnt vmcnt(20)
    ds_add_u32 v5, v19
    buffer_load_dwordx4 v8, s[24:27], s21 offen nt lds
    s_add_u32 s42, s42, 1
    s_waitcnt vmcnt(21)
    buffer_load_dwordx4 v9, s[24:27], s21 offen offset:1024 nt lds
    s_add_u32 s48, s48, 0x2000
    s_waitcnt vmcnt(21)
    buffer_load_dwordx4 v10, s[24:27], s21 offen offset:2048 nt lds
    ds_read_b32 v21, v22
    s_waitcnt vmcnt(21)
    buffer_load_dwordx4 v11, s[24:27], s21 offen offset:3072 nt lds
    s_and_b32 m0, s59, 0x1ffff
    s_waitcnt vmcnt(20)
    ds_add_u32 v5, v19
    buffer_load_dwordx4 v12, s[28:31], s58 offen nt lds
    v_readlane_b32 s21, v16, s42
    s_waitcnt vmcnt(21)
    buffer_load_dwordx4 v13, s[28:31], s58 offen offset:1024 nt lds
    s_add_u32 s59, s59, 0x2000
    s_waitcnt vmcnt(21)
    buffer_load_dwordx4 v14, s[28:31], s58 offen offset:2048 nt lds
    s_waitcnt vmcnt(21)
    buffer_load_dwordx4 v15, s[28:31], s58 offen offset:3072 nt lds
    v_readlane_b32 s58, v28, s42
    s_branch L_w87_top
L_w87_evt:
    s_cmp_eq_u32 s42, s44
    s_cbranch_scc1 L_rare
L_w87_slow:
    s_waitcnt lgkmcnt(0)
    v_readlane_b32 s60, v21, 0
    v_readlane_b32 s61, v21, 1
    v_readlane_b32 s62, v21, 2
    v_readlane_b32 s63, v21, 3
    ds_read_b32 v21, v22
    s_min_u32 s60, s60, s61
    s_min_u32 s62, s62, s63
    s_min_u32 s47, s60, s62
    s_add_u32 s47, s47, 16
    s_min_u32 s43, s44, s47
    s_cmp_lt_u32 s42, s47
    s_cbranch_scc1 L_w87_go
    s_branch L_w87_slow
L_w88:
    v_mov_b32 v6, s54
    v_add_u32 v6, -9, v6
    s_waitcnt vmcnt(24)
    ds_write_b32 v5, v6
    s_branch L_w88_evt
L_w88_top:
    s_cmp_ge_u32 s42, s43
    s_cbranch_scc1 L_w88_evt
L_w88_go:
    s_and_b32 m0, s48, 0x1ffff
    s_waitcnt vmcnt(21)
    buffer_load_dwordx4 v8, s[24:27], s21 offen nt lds
    s_add_u32 s42, s42, 1
    s_waitcnt vmcnt(21)
    ds_add_u32 v5, v19
    buffer_load_dwordx4 v9, s[24:27], s21 offen offset:1024 nt lds
    s_add_u32 s48, s48, 0x2000
    s_waitcnt vmcnt(21)
    buffer_load_dwordx4 v10, s[24:27], s21 offen offset:2048 nt lds
    ds_read_b32 v21, v22
    s_waitcnt vmcnt(21)
    buffer_load_dwordx4 v11, s[24:27], s21 offen offset:3072 nt lds
    s_and_b32 m0, s59, 0x1ffff
    s_waitcnt vmcnt(21)
    buffer_load_dwordx4 v12, s[28:31], s58 offen nt lds
    v_readlane_b32 s21, v16, s42
    s_waitcnt vmcnt(21)
    ds_add_u32 v5, v19
    buffer_load_dwordx4 v13, s[28:31], s58 offen offset:1024 nt lds
    s_add_u32 s59, s59, 0x2000
    s_waitcnt vmcnt(21)
    buffer_load_dwordx4 v14, s[28:31], s58 offen offset:2048 nt lds
    s_waitcnt vmcnt(21)
    buffer_load_dwordx4 v15, s[28:31], s58 offen offset:3072 nt lds
    v_readlane_b32 s58, v28, s42
    s_branch L_w88_top
L_w88_evt:
    s_cmp_eq_u32 s42, s44
    s_cbranch_scc1 L_rare
L_w88_slow:
    s_waitcnt lgkmcnt(0)
    v_readlane_b32 s60, v21, 0
    v_readlane_b32 s61, v21, 1
    v_readlane_b32 s62, v21, 2
    v_readlane_b32 s63, v21, 3
    ds_read_b32 v21, v22
    s_min_u32 s60, s60, s61
    s_min_u32 s62, s62, s63
    s_min_u32 s47, s60, s62
    s_add_u32 s47, s47, 16
    s_min_u32 s43, s44, s47
    s_cmp_lt_u32 s42, s47
    s_cbranch_scc1 L_w88_go
    s_branch L_w88_slow
L_w89:
    v_mov_b32 v6, s54
    v_add_u32 v6, -9, v6
    s_waitcnt vmcnt(24)
    ds_write_b32 v5, v6
    s_branch L_w89_evt
L_w89_top:
    s_cmp_ge_u32 s42, s43
    s_cbranch_scc1 L_w89_evt
L_w89_go:
    s_and_b32 m0, s48, 0x1ffff
    s_waitcnt vmcnt(21)
    buffer_load_dwordx4 v8, s[24:27], s21 offen nt lds
    s_add_u32 s42, s42, 1
    s_waitcnt vmcnt(21)
    ds_add_u32 v5, v19
    buffer_load_dwordx4 v9, s[24:27], s21 offen offset:1024 nt lds
    s_add_u32 s48, s48, 0x2000
    s_waitcnt vmcnt(21)
    buffer_load_dwordx4 v10, s[24:27], s21 offen offset:2048 nt lds
    ds_read_b32 v21, v22
    s_waitcnt vmcnt(22)
    buffer_load_dwordx4 v11, s[24:27], s21 offen offset:3072 nt lds
    s_and_b32 m0, s59, 0x1ffff
    s_waitcnt vmcnt(21)
    buffer_load_dwordx4 v12, s[28:31], s58 offen nt lds
    v_readlane_b32 s21, v16, s42
    s_waitcnt vmcnt(21)
    ds_add_u32 v5, v19
    buffer_load_dwordx4 v13, s[28:31], s58 offen offset:1024 nt lds
    s_add_u32 s59, s59, 0x2000
    s_waitcnt vmcnt(21)
    buffer_load_dwordx4 v14, s[28:31], s58 offen offset:2048 nt lds
    s_waitcnt vmcnt(22)
    buffer_load_dwordx4 v15, s[28:31], s58 offen offset:3072 nt lds
    v_readlane_b32 s58, v28, s42
    s_branch L_w89_top
L_w89_evt:
    s_cmp_eq_u32 s42, s44
    s_cbranch_scc1 L_rare
L_w89_slow:
    s_waitcnt lgkmcnt(0)
    v_readlane_b32 s60, v21, 0
    v_readlane_b32 s61, v21, 1
    v_readlane_b32 s62, v21, 2
    v_readlane_b32 s63, v21, 3
    ds_read_b32 v21, v22
    s_min_u32 s60, s60, s61
    s_min_u32 s62, s62, s63
    s_min_u32 s47, s60, s62
    s_add_u32 s47, s47, 16
    s_min_u32 s43, s44, s47
    s_cmp_lt_u32 s42, s47
    s_cbranch_scc1 L_w89_go
    s_branch L_w89_slow
L_w90:
    v_mov_b32 v6, s54
    v_add_u32 v6, -9, v6
    s_waitcnt vmcnt(24)
    ds_write_b32 v5, v6
    s_branch L_w90_evt
L_w90_top:
    s_cmp_ge_u32 s42, s43
    s_cbranch_scc1 L_w90_evt
L_w90_go:
    s_and_b32 m0, s48, 0x1ffff
    s_waitcnt vmcnt(21)
    buffer_load_dwordx4 v8, s[24:27], s21 offen nt lds
    s_add_u32 s42, s42, 1
    s_waitcnt vmcnt(22)
    buffer_load_dwordx4 v9, s[24:27], s21 offen offset:1024 nt lds
    s_add_u32 s48, s48, 0x2000
    s_waitcnt vmcnt(21)
    ds_add_u32 v5, v19
    buffer_load_dwordx4 v10, s[24:27], s21 offen offset:2048 nt lds
    ds_read_b32 v21, v22
    s_waitcnt vmcnt(22)
    buffer_load_dwordx4 v11, s[24:27], s21 offen offset:3072 nt lds
    s_and_b32 m0, s59, 0x1ffff
    s_waitcnt vmcnt(21)
    buffer_load_dwordx4 v12, s[28:31], s58 offen nt lds
    v_readlane_b32 s21, v16, s42
    s_waitcnt vmcnt(22)
    buffer_load_dwordx4 v13, s[28:31], s58 offen offset:1024 nt lds
    s_add_u32 s59, s59, 0x2000
    s_waitcnt vmcnt(21)
    ds_add_u32 v5, v19
    buffer_load_dwordx4 v14, s[28:31], s58 offen offset:2048 nt lds
    s_waitcnt vmcnt(22)
    buffer_load_dwordx4 v15, s[28:31], s58 offen offset:3072 nt lds
    v_readlane_b32 s58, v28, s42
    s_branch L_w90_top
L_w90_evt:
    s_cmp_eq_u32 s42, s44
    s_cbranch_scc1 L_rare
L_w90_slow:
    s_waitcnt lgkmcnt(0)
    v_readlane_b32 s60, v21, 0
    v_readlane_b32 s61, v21, 1
    v_readlane_b32 s62, v21, 2
    v_readlane_b32 s63, v21, 3
    ds_read_b32 v21, v22
    s_min_u32 s60, s60, s61
    s_min_u32 s62, s62, s63
    s_min_u32 s47, s60, s62
    s_add_u32 s47, s47, 16
    s_min_u32 s43, s44, s47
    s_cmp_lt_u32 s42, s47
    s_cbranch_scc1 L_w90_go
    s_branch L_w90_slow
L_w91:
    v_mov_b32 v6, s54
    v_add_u32 v6, -9, v6
    s_waitcnt vmcnt(24)
    ds_write_b32 v5, v6
    s_branch L_w91_evt
L_w91_top:
    s_cmp_ge_u32 s42, s43
    s_cbranch_scc1 L_w91_evt
L_w91_go:
    s_and_b32 m0, s48, 0x1ffff
    s_waitcnt vmcnt(21)
    buffer_load_dwordx4 v8, s[24:27], s21 offen nt lds
    s_add_u32 s42, s42, 1
    s_waitcnt vmcnt(22)
    buffer_load_dwordx4 v9, s[24:27], s21 offen offset:1024 nt lds
    s_add_u32 s48, s48, 0x2000
    s_waitcnt vmcnt(22)
    ds_add_u32 v5, v19
    buffer_load_dwordx4 v10, s[24:27], s21 offen offset:2048 nt lds
    ds_read_b32 v21, v22
    s_waitcnt vmcnt(22)
    buffer_load_dwordx4 v11, s[24:27], s21 offen offset:3072 nt lds
    s_and_b32 m0, s59, 0x1ffff
    s_waitcnt vmcnt(21)
    buffer_load_dwordx4 v12, s[28:31], s58 offen nt lds
    v_readlane_b32 s21, v16, s42
    s_waitcnt vmcnt(22)
    buffer_load_dwordx4 v13, s[28:31], s58 offen offset:1024 nt lds
    s_add_u32 s59, s59, 0x2000
    s_waitcnt vmcnt(22)
    ds_add_u32 v5, v19
    buffer_load_dwordx4 v14, s[28:31], s58 offen offset:2048 nt lds
    s_waitcnt vmcnt(22)
    buffer_load_dwordx4 v15, s[28:31], s58 offen offset:3072 nt lds
    v_readlane_b32 s58, v28, s42
    s_branch L_w91_top
L_w91_evt:
    s_cmp_eq_u32 s42, s44
    s_cbranch_scc1 L_rare
L_w91_slow:
    s_waitcnt lgkmcnt(0)
    v_readlane_b32 s60, v21, 0
    v_readlane_b32 s61, v21, 1
    v_readlane_b32 s62, v21, 2
    v_readlane_b32 s63, v21, 3
    ds_read_b32 v21, v22
    s_min_u32 s60, s60, s61
    s_min_u32 s62, s62, s63
    s_min_u32 s47, s60, s62
    s_add_u32 s47, s47, 16
    s_min_u32 s43, s44, s47
    s_cmp_lt_u32 s42, s47
    s_cbranch_scc1 L_w91_go
    s_branch L_w91_slow
L_w92:
    v_mov_b32 v6, s54
    v_add_u32 v6, -9, v6
    s_waitcnt vmcnt(24)
    ds_write_b32 v5, v6
    s_branch L_w92_evt
L_w92_top:
    s_cmp_ge_u32 s42, s43
    s_cbranch_scc1 L_w92_evt
L_w92_go:
    s_and_b32 m0, s48, 0x1ffff
    s_waitcnt vmcnt(22)
    buffer_load_dwordx4 v8, s[24:27], s21 offen nt lds
    s_add_u32 s42, s42, 1
    s_waitcnt vmcnt(22)
    buffer_load_dwordx4 v9, s[24:27], s21 offen offset:1024 nt lds
    s_add_u32 s48, s48, 0x2000
    s_waitcnt vmcnt(22)
    ds_add_u32 v5, v19
    buffer_load_dwordx4 v10, s[24:27], s21 offen offset:2048 nt lds
    ds_read_b32 v21, v22
    s_waitcnt vmcnt(22)
    buffer_load_dwordx4 v11, s[24:27], s21 offen offset:3072 nt lds
    s_and_b32 m0, s59, 0x1ffff
    s_waitcnt vmcnt(22)
    buffer_load_dwordx4 v12, s[28:31], s58 offen nt lds
    v_readlane_b32 s21, v16, s42
    s_waitcnt vmcnt(22)
    buffer_load_dwordx4 v13, s[28:31], s58 offen offset:1024 nt lds
    s_add_u32 s59, s59, 0x2000
    s_waitcnt vmcnt(22)
    ds_add_u32 v5, v19
    buffer_load_dwordx4 v14, s[28:31], s58 offen offset:2048 nt lds
    s_waitcnt vmcnt(22)
    buffer_load_dwordx4 v15, s[28:31], s58 offen offset:3072 nt lds
    v_readlane_b32 s58, v28, s42
    s_branch L_w92_top
L_w92_evt:
    s_cmp_eq_u32 s42, s44
    s_cbranch_scc1 L_rare
L_w92_slow:
    s_waitcnt lgkmcnt(0)
    v_readlane_b32 s60, v21, 0
    v_readlane_b32 s61, v21, 1
    v_readlane_b32 s62, v21, 2
    v_readlane_b32 s63, v21, 3
    ds_read_b32 v21, v22
    s_min_u32 s60, s60, s61
    s_min_u32 s62, s62, s63
    s_min_u32 s47, s60, s62
    s_add_u32 s47, s47, 16
    s_min_u32 s43, s44, s47
    s_cmp_lt_u32 s42, s47
    s_cbranch_scc1 L_w92_go
    s_branch L_w92_slow
L_w93:
    v_mov_b32 v6, s54
    v_add_u32 v6, -9, v6
    s_waitcnt vmcnt(24)
    ds_write_b32 v5, v6
    s_branch L_w93_evt
L_w93_top:
    s_cmp_ge_u32 s42, s43
    s_cbranch_scc1 L_w93_evt
L_w93_go:
    s_and_b32 m0, s48, 0x1ffff
    s_waitcnt vmcnt(22)
    buffer_load_dwordx4 v8, s[24:27], s21 offen nt lds
    s_add_u32 s42, s42, 1
    s_waitcnt vmcnt(22)
    buffer_load_dwordx4 v9, s[24:27], s21 offen offset:1024 nt lds
    s_add_u32 s48, s48, 0x2000
    s_waitcnt vmcnt(22)
    ds_add_u32 v5, v19
    buffer_load_dwordx4 v10, s[24:27], s21 offen offset:2048 nt lds
    ds_read_b32 v21, v22
    s_waitcnt vmcnt(23)
    buffer_load_dwordx4 v11, s[24:27], s21 offen offset:3072 nt lds
    s_and_b32 m0, s59, 0x1ffff
    s_waitcnt vmcnt(22)
    buffer_load_dwordx4 v12, s[28:31], s58 offen nt lds
    v_readlane_b32 s21, v16, s42
    s_waitcnt vmcnt(22)
    buffer_load_dwordx4 v13, s[28:31], s58 offen offset:1024 nt lds
    s_add_u32 s59, s59, 0x2000
    s_waitcnt vmcnt(22)
    ds_add_u32 v5, v19
    buffer_load_dwordx4 v14, s[28:31], s58 offen offset:2048 nt lds
    s_waitcnt vmcnt(23)
    buffer_load_dwordx4 v15, s[28:31], s58 offen offset:3072 nt lds
    v_readlane_b32 s58, v28, s42
    s_branch L_w93_top
L_w93_evt:
    s_cmp_eq_u32 s42, s44
    s_cbranch_scc1 L_rare
L_w93_slow:
    s_waitcnt lgkmcnt(0)
    v_readlane_b32 s60, v21, 0
    v_readlane_b32 s61, v21, 1
    v_readlane_b32 s62, v21, 2
    v_readlane_b32 s63, v21, 3
    ds_read_b32 v21, v22
    s_min_u32 s60, s60, s61
    s_min_u32 s62, s62, s63
    s_min_u32 s47, s60, s62
    s_add_u32 s47, s47, 16
    s_min_u32 s43, s44, s47
    s_cmp_lt_u32 s42, s47
    s_cbranch_scc1 L_w93_go
    s_branch L_w93_slow
L_w94:
    v_mov_b32 v6, s54
    v_add_u32 v6, -9, v6
    s_waitcnt vmcnt(24)
    ds_write_b32 v5, v6
    s_branch L_w94_evt
L_w94_top:
    s_cmp_ge_u32 s42, s43
    s_cbranch_scc1 L_w94_evt
L_w94_go:
    s_and_b32 m0, s48, 0x1ffff
    s_waitcnt vmcnt(22)
    buffer_load_dwordx4 v8, s[24:27], s21 offen nt lds
    s_add_u32 s42, s42, 1
    s_waitcnt vmcnt(23)
    buffer_load_dwordx4 v9, s[24:27], s21 offen offset:1024 nt lds
    s_add_u32 s48, s48, 0x2000
    s_waitcnt vmcnt(22)
    ds_add_u32 v5, v19
    buffer_load_dwordx4 v10, s[24:27], s21 offen offset:2048 nt lds
    ds_read_b32 v21, v22
    s_waitcnt vmcnt(23)
    buffer_load_dwordx4 v11, s[24:27], s21 offen offset:3072 nt lds
    s_and_b32 m0, s59, 0x1ffff
    s_waitcnt vmcnt(22)
    buffer_load_dwordx4 v12, s[28:31], s58 offen nt lds
    v_readlane_b32 s21, v16, s42
    s_waitcnt vmcnt(23)
    buffer_load_dwordx4 v13, s[28:31], s58 offen offset:1024 nt lds
    s_add_u32 s59, s59, 0x2000
    s_waitcnt vmcnt(22)
    ds_add_u32 v5, v19
    buffer_load_dwordx4 v14, s[28:31], s58 offen offset:2048 nt lds
    s_waitcnt vmcnt(23)
    buffer_load_dwordx4 v15, s[28:31], s58 offen offset:3072 nt lds
    v_readlane_b32 s58, v28, s42
    s_branch L_w94_top
L_w94_evt:
    s_cmp_eq_u32 s42, s44
    s_cbranch_scc1 L_rare
L_w94_slow:
    s_waitcnt lgkmcnt(0)
    v_readlane_b32 s60, v21, 0
    v_readlane_b32 s61, v21, 1
    v_readlane_b32 s62, v21, 2
    v_readlane_b32 s63, v21, 3
    ds_read_b32 v21, v22
    s_min_u32 s60, s60, s61
    s_min_u32 s62, s62, s63
    s_min_u32 s47, s60, s62
    s_add_u32 s47, s47, 16
    s_min_u32 s43, s44, s47
    s_cmp_lt_u32 s42, s47
    s_cbranch_scc1 L_w94_go
    s_branch L_w94_slow
L_w95:
    v_mov_b32 v6, s54
    v_add_u32 v6, -9, v6
    s_waitcnt vmcnt(24)
    ds_write_b32 v5, v6
    s_branch L_w95_evt
L_w95_top:
    s_cmp_ge_u32 s42, s43
    s_cbranch_scc1 L_w95_evt
L_w95_go:
    s_and_b32 m0, s48, 0x1ffff
    s_waitcnt vmcnt(22)
    buffer_load_dwordx4 v8, s[24:27], s21 offen nt lds
    s_add_u32 s42, s42, 1
    s_waitcnt vmcnt(23)
    buffer_load_dwordx4 v9, s[24:27], s21 offen offset:1024 nt lds
    s_add_u32 s48, s48, 0x2000
    s_waitcnt vmcnt(23)
    buffer_load_dwordx4 v10, s[24:27], s21 offen offset:2048 nt lds
    ds_read_b32 v21, v22
    s_waitcnt vmcnt(23)
    ds_add_u32 v5, v19
    buffer_load_dwordx4 v11, s[24:27], s21 offen offset:3072 nt lds
    s_and_b32 m0, s59, 0x1ffff
    s_waitcnt vmcnt(22)
    buffer_load_dwordx4 v12, s[28:31], s58 offen nt lds
    v_readlane_b32 s21, v16, s42
    s_waitcnt vmcnt(23)
    buffer_load_dwordx4 v13, s[28:31], s58 offen offset:1024 nt lds
    s_add_u32 s59, s59, 0x2000
    s_waitcnt vmcnt(23)
    buffer_load_dwordx4 v14, s[28:31], s58 offen offset:2048 nt lds
    s_waitcnt vmcnt(23)
    ds_add_u32 v5, v19
    buffer_load_dwordx4 v15, s[28:31], s58 offen offset:3072 nt lds
    v_readlane_b32 s58, v28, s42
    s_branch L_w95_top
L_w95_evt:
    s_cmp_eq_u32 s42, s44
    s_cbranch_scc1 L_rare
L_w95_slow:
    s_waitcnt lgkmcnt(0)
    v_readlane_b32 s60, v21, 0
    v_readlane_b32 s61, v21, 1
    v_readlane_b32 s62, v21, 2
    v_readlane_b32 s63, v21, 3
    ds_read_b32 v21, v22
    s_min_u32 s60, s60, s61
    s_min_u32 s62, s62, s63
    s_min_u32 s47, s60, s62
    s_add_u32 s47, s47, 16
    s_min_u32 s43, s44, s47
    s_cmp_lt_u32 s42, s47
    s_cbranch_scc1 L_w95_go
    s_branch L_w95_slow
L_w96:
    v_mov_b32 v6, s54
    v_add_u32 v6, -9, v6
    s_waitcnt vmcnt(24)
    ds_write_b32 v5, v6
    s_branch L_w96_evt
L_w96_top:
    s_cmp_ge_u32 s42, s43
    s_cbranch_scc1 L_w96_evt
L_w96_go:
    s_and_b32 m0, s48, 0x1ffff
    s_waitcnt vmcnt(23)
    buffer_load_dwordx4 v8, s[24:27], s21 offen nt lds
    s_add_u32 s42, s42, 1
    s_waitcnt vmcnt(23)
    buffer_load_dwordx4 v9, s[24:27], s21 offen offset:1024 nt lds
    s_add_u32 s48, s48, 0x2000
    s_waitcnt vmcnt(23)
    buffer_load_dwordx4 v10, s[24:27], s21 offen offset:2048 nt lds
    ds_read_b32 v21, v22
    s_waitcnt vmcnt(23)
    ds_add_u32 v5, v19
    buffer_load_dwordx4 v11, s[24:27], s21 offen offset:3072 nt lds
    s_and_b32 m0, s59, 0x1ffff
    s_waitcnt vmcnt(23)
    buffer_load_dwordx4 v12, s[28:31], s58 offen nt lds
    v_readlane_b32 s21, v16, s42
    s_waitcnt vmcnt(23)
    buffer_load_dwordx4 v13, s[28:31], s58 offen offset:1024 nt lds
    s_add_u32 s59, s59, 0x2000
    s_waitcnt vmcnt(23)
    buffer_load_dwordx4 v14, s[28:31], s58 offen offset:2048 nt lds
    s_waitcnt vmcnt(23)
    ds_add_u32 v5, v19
    buffer_load_dwordx4 v15, s[28:31], s58 offen offset:3072 nt lds
    v_readlane_b32 s58, v28, s42
    s_branch L_w96_top
L_w96_evt:
    s_cmp_eq_u32 s42, s44
    s_cbranch_scc1 L_rare
L_w96_slow:
    s_waitcnt lgkmcnt(0)
    v_readlane_b32 s60, v21, 0
    v_readlane_b32 s61, v21, 1
    v_readlane_b32 s62, v21, 2
    v_readlane_b32 s63, v21, 3
    ds_read_b32 v21, v22
    s_min_u32 s60, s60, s61
    s_min_u32 s62, s62, s63
    s_min_u32 s47, s60, s62
    s_add_u32 s47, s47, 16
    s_min_u32 s43, s44, s47
    s_cmp_lt_u32 s42, s47
    s_cbranch_scc1 L_w96_go
    s_branch L_w96_slow
L_w97:
    v_mov_b32 v6, s54
    v_add_u32 v6, -10, v6
    s_waitcnt vmcnt(28)
    ds_write_b32 v5, v6
    s_branch L_w97_evt
L_w97_top:
    s_cmp_ge_u32 s42, s43
    s_cbranch_scc1 L_w97_evt
L_w97_go:
    s_and_b32 m0, s48, 0x1ffff
    s_waitcnt vmcnt(23)
    ds_add_u32 v5, v19
    buffer_load_dwordx4 v8, s[24:27], s21 offen nt lds
    s_add_u32 s42, s42, 1
    s_waitcnt vmcnt(23)
    buffer_load_dwordx4 v9, s[24:27], s21 offen offset:1024 nt lds
    s_add_u32 s48, s48, 0x2000
    s_waitcnt vmcnt(23)
    buffer_load_dwordx4 v10, s[24:27], s21 offen offset:2048 nt lds
    ds_read_b32 v21, v22
    s_waitcnt vmcnt(24)
    buffer_load_dwordx4 v11, s[24:27], s21 offen offset:3072 nt lds
    s_and_b32 m0, s59, 0x1ffff
    s_waitcnt vmcnt(23)
    ds_add_u32 v5, v19
    buffer_load_dwordx4 v12, s[28:31], s58 offen nt lds
    v_readlane_b32 s21, v16, s42
    s_waitcnt vmcnt(23)
    buffer_load_dwordx4 v13, s[28:31], s58 offen offset:1024 nt lds
    s_add_u32 s59, s59, 0x2000
    s_waitcnt vmcnt(23)
    buffer_load_dwordx4 v14, s[28:31], s58 offen offset:2048 nt lds
    s_waitcnt vmcnt(24)
    buffer_load_dwordx4 v15, s[28:31], s58 offen offset:3072 nt lds
    v_readlane_b32 s58, v28, s42
    s_branch L_w97_top
L_w97_evt:
    s_cmp_eq_u32 s42, s44
    s_cbranch_scc1 L_rare
L_w97_slow:
    s_waitcnt lgkmcnt(0)
    v_readlane_b32 s60, v21, 0
    v_readlane_b32 s61, v21, 1
    v_readlane_b32 s62, v21, 2
    v_readlane_b32 s63, v21, 3
    ds_read_b32 v21, v22
    s_min_u32 s60, s60, s61
    s_min_u32 s62, s62, s63
    s_min_u32 s47, s60, s62
    s_add_u32 s47, s47, 16
    s_min_u32 s43, s44, s47
    s_cmp_lt_u32 s42, s47
    s_cbranch_scc1 L_w97_go
    s_branch L_w97_slow
L_w98:
    v_mov_b32 v6, s54
    v_add_u32 v6, -10, v6
    s_waitcnt vmcnt(28)
    ds_write_b32 v5, v6
    s_branch L_w98_evt
L_w98_top:
    s_cmp_ge_u32 s42, s43
    s_cbranch_scc1 L_w98_evt
L_w98_go:
    s_and_b32 m0, s48, 0x1ffff
    s_waitcnt vmcnt(23)
    ds_add_u32 v5, v19
    buffer_load_dwordx4 v8, s[24:27], s21 offen nt lds
    s_add_u32 s42, s42, 1
    s_waitcnt vmcnt(24)
    buffer_load_dwordx4 v9, s[24:27], s21 offen offset:1024 nt lds
    s_add_u32 s48, s48, 0x2000
    s_waitcnt vmcnt(23)
    buffer_load_dwordx4 v10, s[24:27], s21 offen offset:2048 nt lds
    ds_read_b32 v21, v22
    s_waitcnt vmcnt(24)
    buffer_load_dwordx4 v11, s[24:27], s21 offen offset:3072 nt lds
    s_and_b32 m0, s59, 0x1ffff
    s_waitcnt vmcnt(23)
    ds_add_u32 v5, v19
    buffer_load_dwordx4 v12, s[28:31], s58 offen nt lds
    v_readlane_b32 s21, v16, s42
    s_waitcnt vmcnt(24)
    buffer_load_dwordx4 v13, s[28:31], s58 offen offset:1024 nt lds
    s_add_u32 s59, s59, 0x2000
    s_waitcnt vmcnt(23)
    buffer_load_dwordx4 v14, s[28:31], s58 offen offset:2048 nt lds
    s_waitcnt vmcnt(24)
    buffer_load_dwordx4 v15, s[28:31], s58 offen offset:3072 nt lds
    v_readlane_b32 s58, v28, s42
    s_branch L_w98_top
L_w98_evt:
    s_cmp_eq_u32 s42, s44
    s_cbranch_scc1 L_rare
L_w98_slow:
    s_waitcnt lgkmcnt(0)
    v_readlane_b32 s60, v21, 0
    v_readlane_b32 s61, v21, 1
    v_readlane_b32 s62, v21, 2
    v_readlane_b32 s63, v21, 3
    ds_read_b32 v21, v22
    s_min_u32 s60, s60, s61
    s_min_u32 s62, s62, s63
    s_min_u32 s47, s60, s62
    s_add_u32 s47, s47, 16
    s_min_u32 s43, s44, s47
    s_cmp_lt_u32 s42, s47
    s_cbranch_scc1 L_w98_go
    s_branch L_w98_slow
L_w99:
    v_mov_b32 v6, s54
    v_add_u32 v6, -10, v6
    s_waitcnt vmcnt(28)
    ds_write_b32 v5, v6
    s_branch L_w99_evt
L_w99_top:
    s_cmp_ge_u32 s42, s43
    s_cbranch_scc1 L_w99_evt
L_w99_go:
    s_and_b32 m0, s48, 0x1ffff
    s_waitcnt vmcnt(23)
    ds_add_u32 v5, v19
    buffer_load_dwordx4 v8, s[24:27], s21 offen nt lds
    s_add_u32 s42, s42, 1
    s_waitcnt vmcnt(24)
    buffer_load_dwordx4 v9, s[24:27], s21 offen offset:1024 nt lds
    s_add_u32 s48, s48, 0x2000
    s_waitcnt vmcnt(24)
    buffer_load_dwordx4 v10, s[24:27], s21 offen offset:2048 nt lds
    ds_read_b32 v21, v22
    s_waitcnt vmcnt(24)
    buffer_load_dwordx4 v11, s[24:27], s21 offen offset:3072 nt lds
    s_and_b32 m0, s59, 0x1ffff
    s_waitcnt vmcnt(23)
    ds_add_u32 v5, v19
    buffer_load_dwordx4 v12, s[28:31], s58 offen nt lds
    v_readlane_b32 s21, v16, s42
    s_waitcnt vmcnt(24)
    buffer_load_dwordx4 v13, s[28:31], s58 offen offset:1024 nt lds
    s_add_u32 s59, s59, 0x2000
    s_waitcnt vmcnt(24)
    buffer_load_dwordx4 v14, s[28:31], s58 offen offset:2048 nt lds
    s_waitcnt vmcnt(24)
    buffer_load_dwordx4 v15, s[28:31], s58 offen offset:3072 nt lds
    v_readlane_b32 s58, v28, s42
    s_branch L_w99_top
L_w99_evt:
    s_cmp_eq_u32 s42, s44
    s_cbranch_scc1 L_rare
L_w99_slow:
    s_waitcnt lgkmcnt(0)
    v_readlane_b32 s60, v21, 0
    v_readlane_b32 s61, v21, 1
    v_readlane_b32 s62, v21, 2
    v_readlane_b32 s63, v21, 3
    ds_read_b32 v21, v22
    s_min_u32 s60, s60, s61
    s_min_u32 s62, s62, s63
    s_min_u32 s47, s60, s62
    s_add_u32 s47, s47, 16
    s_min_u32 s43, s44, s47
    s_cmp_lt_u32 s42, s47
    s_cbranch_scc1 L_w99_go
    s_branch L_w99_slow
L_w100:
    v_mov_b32 v6, s54
    v_add_u32 v6, -10, v6
    s_waitcnt vmcnt(28)
    ds_write_b32 v5, v6
    s_branch L_w100_evt
L_w100_top:
    s_cmp_ge_u32 s42, s43
    s_cbranch_scc1 L_w100_evt
L_w100_go:
    s_and_b32 m0, s48, 0x1ffff
    s_waitcnt vmcnt(24)
    ds_add_u32 v5, v19
    buffer_load_dwordx4 v8, s[24:27], s21 offen nt lds
    s_add_u32 s42, s42, 1
    s_waitcnt vmcnt(24)
    buffer_load_dwordx4 v9, s[24:27], s21 offen offset:1024 nt lds
    s_add_u32 s48, s48, 0x2000
    s_waitcnt vmcnt(24)
    buffer_load_dwordx4 v10, s[24:27], s21 offen offset:2048 nt lds
    ds_read_b32 v21, v22
    s_waitcnt vmcnt(24)
    buffer_load_dwordx4 v11, s[24:27], s21 offen offset:3072 nt lds
    s_and_b32 m0, s59, 0x1ffff
    s_waitcnt vmcnt(24)
    ds_add_u32 v5, v19
    buffer_load_dwordx4 v12, s[28:31], s58 offen nt lds
    v_readlane_b32 s21, v16, s42
    s_waitcnt vmcnt(24)
    buffer_load_dwordx4 v13, s[28:31], s58 offen offset:1024 nt lds
    s_add_u32 s59, s59, 0x2000
    s_waitcnt vmcnt(24)
    buffer_load_dwordx4 v14, s[28:31], s58 offen offset:2048 nt lds
    s_waitcnt vmcnt(24)
    buffer_load_dwordx4 v15, s[28:31], s58 offen offset:3072 nt lds
    v_readlane_b32 s58, v28, s42
    s_branch L_w100_top
L_w100_evt:
    s_cmp_eq_u32 s42, s44
    s_cbranch_scc1 L_rare
L_w100_slow:
    s_waitcnt lgkmcnt(0)
    v_readlane_b32 s60, v21, 0
    v_readlane_b32 s61, v21, 1
    v_readlane_b32 s62, v21, 2
    v_readlane_b32 s63, v21, 3
    ds_read_b32 v21, v22
    s_min_u32 s60, s60, s61
    s_min_u32 s62, s62, s63
    s_min_u32 s47, s60, s62
    s_add_u32 s47, s47, 16
    s_min_u32 s43, s44, s47
    s_cmp_lt_u32 s42, s47
    s_cbranch_scc1 L_w100_go
    s_branch L_w100_slow
L_w101:
    v_mov_b32 v6, s54
    v_add_u32 v6, -10, v6
    s_waitcnt vmcnt(28)
    ds_write_b32 v5, v6
    s_branch L_w101_evt
L_w101_top:
    s_cmp_ge_u32 s42, s43
    s_cbranch_scc1 L_w101_evt
L_w101_go:
    s_and_b32 m0, s48, 0x1ffff
    s_waitcnt vmcnt(24)
    ds_add_u32 v5, v19
    buffer_load_dwordx4 v8, s[24:27], s21 offen nt lds
    s_add_u32 s42, s42, 1
    s_waitcnt vmcnt(24)
    buffer_load_dwordx4 v9, s[24:27], s21 offen offset:1024 nt lds
    s_add_u32 s48, s48, 0x2000
    s_waitcnt vmcnt(24)
    buffer_load_dwordx4 v10, s[24:27], s21 offen offset:2048 nt lds
    ds_read_b32 v21, v22
    s_waitcnt vmcnt(25)
    buffer_load_dwordx4 v11, s[24:27], s21 offen offset:3072 nt lds
    s_and_b32 m0, s59, 0x1ffff
    s_waitcnt vmcnt(24)
    ds_add_u32 v5, v19
    buffer_load_dwordx4 v12, s[28:31], s58 offen nt lds
    v_readlane_b32 s21, v16, s42
    s_waitcnt vmcnt(24)
    buffer_load_dwordx4 v13, s[28:31], s58 offen offset:1024 nt lds
    s_add_u32 s59, s59, 0x2000
    s_waitcnt vmcnt(24)
    buffer_load_dwordx4 v14, s[28:31], s58 offen offset:2048 nt lds
    s_waitcnt vmcnt(25)
    buffer_load_dwordx4 v15, s[28:31], s58 offen offset:3072 nt lds
    v_readlane_b32 s58, v28, s42
    s_branch L_w101_top
L_w101_evt:
    s_cmp_eq_u32 s42, s44
    s_cbranch_scc1 L_rare
L_w101_slow:
    s_waitcnt lgkmcnt(0)
    v_readlane_b32 s60, v21, 0
    v_readlane_b32 s61, v21, 1
    v_readlane_b32 s62, v21, 2
    v_readlane_b32 s63, v21, 3
    ds_read_b32 v21, v22
    s_min_u32 s60, s60, s61
    s_min_u32 s62, s62, s63
    s_min_u32 s47, s60, s62
    s_add_u32 s47, s47, 16
    s_min_u32 s43, s44, s47
    s_cmp_lt_u32 s42, s47
    s_cbranch_scc1 L_w101_go
    s_branch L_w101_slow
L_w102:
    v_mov_b32 v6, s54
    v_add_u32 v6, -10, v6
    s_waitcnt vmcnt(28)
    ds_write_b32 v5, v6
    s_branch L_w102_evt
L_w102_top:
    s_cmp_ge_u32 s42, s43
    s_cbranch_scc1 L_w102_evt
L_w102_go:
    s_and_b32 m0, s48, 0x1ffff
    s_waitcnt vmcnt(24)
    ds_add_u32 v5, v19
    buffer_load_dwordx4 v8, s[24:27], s21 offen nt lds
    s_add_u32 s42, s42, 1
    s_waitcnt vmcnt(25)
    buffer_load_dwordx4 v9, s[24:27], s21 offen offset:1024 nt lds
    s_add_u32 s48, s48, 0x2000
    s_waitcnt vmcnt(24)
    buffer_load_dwordx4 v10, s[24:27], s21 offen offset:2048 nt lds
    ds_read_b32 v21, v22
    s_waitcnt vmcnt(25)
    buffer_load_dwordx4 v11, s[24:27], s21 offen offset:3072 nt lds
    s_and_b32 m0, s59, 0x1ffff
    s_waitcnt vmcnt(24)
    ds_add_u32 v5, v19
    buffer_load_dwordx4 v12, s[28:31], s58 offen nt lds
    v_readlane_b32 s21, v16, s42
    s_waitcnt vmcnt(25)
    buffer_load_dwordx4 v13, s[28:31], s58 offen offset:1024 nt lds
    s_add_u32 s59, s59, 0x2000
    s_waitcnt vmcnt(24)
    buffer_load_dwordx4 v14, s[28:31], s58 offen offset:2048 nt lds
    s_waitcnt vmcnt(25)
    buffer_load_dwordx4 v15, s[28:31], s58 offen offset:3072 nt lds
    v_readlane_b32 s58, v28, s42
    s_branch L_w102_top
L_w102_evt:
    s_cmp_eq_u32 s42, s44
    s_cbranch_scc1 L_rare
L_w102_slow:
    s_waitcnt lgkmcnt(0)
    v_readlane_b32 s60, v21, 0
    v_readlane_b32 s61, v21, 1
    v_readlane_b32 s62, v21, 2
    v_readlane_b32 s63, v21, 3
    ds_read_b32 v21, v22
    s_min_u32 s60, s60, s61
    s_min_u32 s62, s62, s63
    s_min_u32 s47, s60, s62
    s_add_u32 s47, s47, 16
    s_min_u32 s43, s44, s47
    s_cmp_lt_u32 s42, s47
    s_cbranch_scc1 L_w102_go
    s_branch L_w102_slow
L_w103:
    v_mov_b32 v6, s54
    v_add_u32 v6, -10, v6
    s_waitcnt vmcnt(28)
    ds_write_b32 v5, v6
    s_branch L_w103_evt
L_w103_top:
    s_cmp_ge_u32 s42, s43
    s_cbranch_scc1 L_w103_evt
L_w103_go:
    s_and_b32 m0, s48, 0x1ffff
    s_waitcnt vmcnt(24)
    ds_add_u32 v5, v19
    buffer_load_dwordx4 v8, s[24:27], s21 offen nt lds
    s_add_u32 s42, s42, 1
    s_waitcnt vmcnt(25)
    buffer_load_dwordx4 v9, s[24:27], s21 offen offset:1024 nt lds
    s_add_u32 s48, s48, 0x2000
    s_waitcnt vmcnt(25)
    buffer_load_dwordx4 v10, s[24:27], s21 offen offset:2048 nt lds
    ds_read_b32 v21, v22
    s_waitcnt vmcnt(25)
    buffer_load_dwordx4 v11, s[24:27], s21 offen offset:3072 nt lds
    s_and_b32 m0, s59, 0x1ffff
    s_waitcnt vmcnt(24)
    ds_add_u32 v5, v19
    buffer_load_dwordx4 v12, s[28:31], s58 offen nt lds
    v_readlane_b32 s21, v16, s42
    s_waitcnt vmcnt(25)
    buffer_load_dwordx4 v13, s[28:31], s58 offen offset:1024 nt lds
    s_add_u32 s59, s59, 0x2000
    s_waitcnt vmcnt(25)
    buffer_load_dwordx4 v14, s[28:31], s58 offen offset:2048 nt lds
    s_waitcnt vmcnt(25)
    buffer_load_dwordx4 v15, s[28:31], s58 offen offset:3072 nt lds
    v_readlane_b32 s58, v28, s42
    s_branch L_w103_top
L_w103_evt:
    s_cmp_eq_u32 s42, s44
    s_cbranch_scc1 L_rare
L_w103_slow:
    s_waitcnt lgkmcnt(0)
    v_readlane_b32 s60, v21, 0
    v_readlane_b32 s61, v21, 1
    v_readlane_b32 s62, v21, 2
    v_readlane_b32 s63, v21, 3
    ds_read_b32 v21, v22
    s_min_u32 s60, s60, s61
    s_min_u32 s62, s62, s63
    s_min_u32 s47, s60, s62
    s_add_u32 s47, s47, 16
    s_min_u32 s43, s44, s47
    s_cmp_lt_u32 s42, s47
    s_cbranch_scc1 L_w103_go
    s_branch L_w103_slow
L_w104:
    v_mov_b32 v6, s54
    v_add_u32 v6, -10, v6
    s_waitcnt vmcnt(28)
    ds_write_b32 v5, v6
    s_branch L_w104_evt
L_w104_top:
    s_cmp_ge_u32 s42, s43
    s_cbranch_scc1 L_w104_evt
L_w104_go:
    s_and_b32 m0, s48, 0x1ffff
    s_waitcnt vmcnt(25)
    buffer_load_dwordx4 v8, s[24:27], s21 offen nt lds
    s_add_u32 s42, s42, 1
    s_waitcnt vmcnt(25)
    ds_add_u32 v5, v19
    buffer_load_dwordx4 v9, s[24:27], s21 offen offset:1024 nt lds
    s_add_u32 s48, s48, 0x2000
    s_waitcnt vmcnt(25)
    buffer_load_dwordx4 v10, s[24:27], s21 offen offset:2048 nt lds
    ds_read_b32 v21, v22
    s_waitcnt vmcnt(25)
    buffer_load_dwordx4 v11, s[24:27], s21 offen offset:3072 nt lds
    s_and_b32 m0, s59, 0x1ffff
    s_waitcnt vmcnt(25)
    buffer_load_dwordx4 v12, s[28:31], s58 offen nt lds
    v_readlane_b32 s21, v16, s42
    s_waitcnt vmcnt(25)
    ds_add_u32 v5, v19
    buffer_load_dwordx4 v13, s[28:31], s58 offen offset:1024 nt lds
    s_add_u32 s59, s59, 0x2000
    s_waitcnt vmcnt(25)
    buffer_load_dwordx4 v14, s[28:31], s58 offen offset:2048 nt lds
    s_waitcnt vmcnt(25)
    buffer_load_dwordx4 v15, s[28:31], s58 offen offset:3072 nt lds
    v_readlane_b32 s58, v28, s42
    s_branch L_w104_top
L_w104_evt:
    s_cmp_eq_u32 s42, s44
    s_cbranch_scc1 L_rare
L_w104_slow:
    s_waitcnt lgkmcnt(0)
    v_readlane_b32 s60, v21, 0
    v_readlane_b32 s61, v21, 1
    v_readlane_b32 s62, v21, 2
    v_readlane_b32 s63, v21, 3
    ds_read_b32 v21, v22
    s_min_u32 s60, s60, s61
    s_min_u32 s62, s62, s63
    s_min_u32 s47, s60, s62
    s_add_u32 s47, s47, 16
    s_min_u32 s43, s44, s47
    s_cmp_lt_u32 s42, s47
    s_cbranch_scc1 L_w104_go
    s_branch L_w104_slow
L_w105:
    v_mov_b32 v6, s54
    v_add_u32 v6, -10, v6
    s_waitcnt vmcnt(28)
    ds_write_b32 v5, v6
    s_branch L_w105_evt
L_w105_top:
    s_cmp_ge_u32 s42, s43
    s_cbranch_scc1 L_w105_evt
L_w105_go:
    s_and_b32 m0, s48, 0x1ffff
    s_waitcnt vmcnt(25)
    buffer_load_dwordx4 v8, s[24:27], s21 offen nt lds
    s_add_u32 s42, s42, 1
    s_waitcnt vmcnt(25)
    ds_add_u32 v5, v19
    buffer_load_dwordx4 v9, s[24:27], s21 offen offset:1024 nt lds
    s_add_u32 s48, s48, 0x2000
    s_waitcnt vmcnt(25)
    buffer_load_dwordx4 v10, s[24:27], s21 offen offset:2048 nt lds
    ds_read_b32 v21, v22
    s_waitcnt vmcnt(26)
    buffer_load_dwordx4 v11, s[24:27], s21 offen offset:3072 nt lds
    s_and_b32 m0, s59, 0x1ffff
    s_waitcnt vmcnt(25)
    buffer_load_dwordx4 v12, s[28:31], s58 offen nt lds
    v_readlane_b32 s21, v16, s42
    s_waitcnt vmcnt(25)
    ds_add_u32 v5, v19
    buffer_load_dwordx4 v13, s[28:31], s58 offen offset:1024 nt lds
    s_add_u32 s59, s59, 0x2000
    s_waitcnt vmcnt(25)
    buffer_load_dwordx4 v14, s[28:31], s58 offen offset:2048 nt lds
    s_waitcnt vmcnt(26)
    buffer_load_dwordx4 v15, s[28:31], s58 offen offset:3072 nt lds
    v_readlane_b32 s58, v28, s42
    s_branch L_w105_top
L_w105_evt:
    s_cmp_eq_u32 s42, s44
    s_cbranch_scc1 L_rare
L_w105_slow:
    s_waitcnt lgkmcnt(0)
    v_readlane_b32 s60, v21, 0
    v_readlane_b32 s61, v21, 1
    v_readlane_b32 s62, v21, 2
    v_readlane_b32 s63, v21, 3
    ds_read_b32 v21, v22
    s_min_u32 s60, s60, s61
    s_min_u32 s62, s62, s63
    s_min_u32 s47, s60, s62
    s_add_u32 s47, s47, 16
    s_min_u32 s43, s44, s47
    s_cmp_lt_u32 s42, s47
    s_cbranch_scc1 L_w105_go
    s_branch L_w105_slow
L_w106:
    v_mov_b32 v6, s54
    v_add_u32 v6, -10, v6
    s_waitcnt vmcnt(28)
    ds_write_b32 v5, v6
    s_branch L_w106_evt
L_w106_top:
    s_cmp_ge_u32 s42, s43
    s_cbranch_scc1 L_w106_evt
L_w106_go:
    s_and_b32 m0, s48, 0x1ffff
    s_waitcnt vmcnt(25)
    buffer_load_dwordx4 v8, s[24:27], s21 offen nt lds
    s_add_u32 s42, s42, 1
    s_waitcnt vmcnt(26)
    buffer_load_dwordx4 v9, s[24:27], s21 offen offset:1024 nt lds
    s_add_u32 s48, s48, 0x2000
    s_waitcnt vmcnt(25)
    ds_add_u32 v5, v19
    buffer_load_dwordx4 v10, s[24:27], s21 offen offset:2048 nt lds
    ds_read_b32 v21, v22
    s_waitcnt vmcnt(26)
    buffer_load_dwordx4 v11, s[24:27], s21 offen offset:3072 nt lds
    s_and_b32 m0, s59, 0x1ffff
    s_waitcnt vmcnt(25)
    buffer_load_dwordx4 v12, s[28:31], s58 offen nt lds
    v_readlane_b32 s21, v16, s42
    s_waitcnt vmcnt(26)
    buffer_load_dwordx4 v13, s[28:31], s58 offen offset:1024 nt lds
    s_add_u32 s59, s59, 0x2000
    s_waitcnt vmcnt(25)
    ds_add_u32 v5, v19
    buffer_load_dwordx4 v14, s[28:31], s58 offen offset:2048 nt lds
    s_waitcnt vmcnt(26)
    buffer_load_dwordx4 v15, s[28:31], s58 offen offset:3072 nt lds
    v_readlane_b32 s58, v28, s42
    s_branch L_w106_top
L_w106_evt:
    s_cmp_eq_u32 s42, s44
    s_cbranch_scc1 L_rare
L_w106_slow:
    s_waitcnt lgkmcnt(0)
    v_readlane_b32 s60, v21, 0
    v_readlane_b32 s61, v21, 1
    v_readlane_b32 s62, v21, 2
    v_readlane_b32 s63, v21, 3
    ds_read_b32 v21, v22
    s_min_u32 s60, s60, s61
    s_min_u32 s62, s62, s63
    s_min_u32 s47, s60, s62
    s_add_u32 s47, s47, 16
    s_min_u32 s43, s44, s47
    s_cmp_lt_u32 s42, s47
    s_cbranch_scc1 L_w106_go
    s_branch L_w106_slow
L_w107:
    v_mov_b32 v6, s54
    v_add_u32 v6, -10, v6
    s_waitcnt vmcnt(28)
    ds_write_b32 v5, v6
    s_branch L_w107_evt
L_w107_top:
    s_cmp_ge_u32 s42, s43
    s_cbranch_scc1 L_w107_evt
L_w107_go:
    s_and_b32 m0, s48, 0x1ffff
    s_waitcnt vmcnt(25)
    buffer_load_dwordx4 v8, s[24:27], s21 offen nt lds
    s_add_u32 s42, s42, 1
    s_waitcnt vmcnt(26)
    buffer_load_dwordx4 v9, s[24:27], s21 offen offset:1024 nt lds
    s_add_u32 s48, s48, 0x2000
    s_waitcnt vmcnt(26)
    ds_add_u32 v5, v19
    buffer_load_dwordx4 v10, s[24:27], s21 offen offset:2048 nt lds
    ds_read_b32 v21, v22
    s_waitcnt vmcnt(26)
    buffer_load_dwordx4 v11, s[24:27], s21 offen offset:3072 nt lds
    s_and_b32 m0, s59, 0x1ffff
    s_waitcnt vmcnt(25)
    buffer_load_dwordx4 v12, s[28:31], s58 offen nt lds
    v_readlane_b32 s21, v16, s42
    s_waitcnt vmcnt(26)
    buffer_load_dwordx4 v13, s[28:31], s58 offen offset:1024 nt lds
    s_add_u32 s59, s59, 0x2000
    s_waitcnt vmcnt(26)
    ds_add_u32 v5, v19
    buffer_load_dwordx4 v14, s[28:31], s58 offen offset:2048 nt lds
    s_waitcnt vmcnt(26)
    buffer_load_dwordx4 v15, s[28:31], s58 offen offset:3072 nt lds
    v_readlane_b32 s58, v28, s42
    s_branch L_w107_top
L_w107_evt:
    s_cmp_eq_u32 s42, s44
    s_cbranch_scc1 L_rare
L_w107_slow:
    s_waitcnt lgkmcnt(0)
    v_readlane_b32 s60, v21, 0
    v_readlane_b32 s61, v21, 1
    v_readlane_b32 s62, v21, 2
    v_readlane_b32 s63, v21, 3
    ds_read_b32 v21, v22
    s_min_u32 s60, s60, s61
    s_min_u32 s62, s62, s63
    s_min_u32 s47, s60, s62
    s_add_u32 s47, s47, 16
    s_min_u32 s43, s44, s47
    s_cmp_lt_u32 s42, s47
    s_cbranch_scc1 L_w107_go
    s_branch L_w107_slow
L_w108:
    v_mov_b32 v6, s54
    v_add_u32 v6, -10, v6
    s_waitcnt vmcnt(28)
    ds_write_b32 v5, v6
    s_branch L_w108_evt
L_w108_top:
    s_cmp_ge_u32 s42, s43
    s_cbranch_scc1 L_w108_evt
L_w108_go:
    s_and_b32 m0, s48, 0x1ffff
    s_waitcnt vmcnt(26)
    buffer_load_dwordx4 v8, s[24:27], s21 offen nt lds
    s_add_u32 s42, s42, 1
    s_waitcnt vmcnt(26)
    buffer_load_dwordx4 v9, s[24:27], s21 offen offset:1024 nt lds
    s_add_u32 s48, s48, 0x2000
    s_waitcnt vmcnt(26)
    ds_add_u32 v5, v19
    buffer_load_dwordx4 v10, s[24:27], s21 offen offset:2048 nt lds
    ds_read_b32 v21, v22
    s_waitcnt vmcnt(26)
    buffer_load_dwordx4 v11, s[24:27], s21 offen offset:3072 nt lds
    s_and_b32 m0, s59, 0x1ffff
    s_waitcnt vmcnt(26)
    buffer_load_dwordx4 v12, s[28:31], s58 offen nt lds
    v_readlane_b32 s21, v16, s42
    s_waitcnt vmcnt(26)
    buffer_load_dwordx4 v13, s[28:31], s58 offen offset:1024 nt lds
    s_add_u32 s59, s59, 0x2000
    s_waitcnt vmcnt(26)
    ds_add_u32 v5, v19
    buffer_load_dwordx4 v14, s[28:31], s58 offen offset:2048 nt lds
    s_waitcnt vmcnt(26)
    buffer_load_dwordx4 v15, s[28:31], s58 offen offset:3072 nt lds
    v_readlane_b32 s58, v28, s42
    s_branch L_w108_top
L_w108_evt:
    s_cmp_eq_u32 s42, s44
    s_cbranch_scc1 L_rare
L_w108_slow:
    s_waitcnt lgkmcnt(0)
    v_readlane_b32 s60, v21, 0
    v_readlane_b32 s61, v21, 1
    v_readlane_b32 s62, v21, 2
    v_readlane_b32 s63, v21, 3
    ds_read_b32 v21, v22
    s_min_u32 s60, s60, s61
    s_min_u32 s62, s62, s63
    s_min_u32 s47, s60, s62
    s_add_u32 s47, s47, 16
    s_min_u32 s43, s44, s47
    s_cmp_lt_u32 s42, s47
    s_cbranch_scc1 L_w108_go
    s_branch L_w108_slow
L_w109:
    v_mov_b32 v6, s54
    v_add_u32 v6, -10, v6
    s_waitcnt vmcnt(28)
    ds_write_b32 v5, v6
    s_branch L_w109_evt
L_w109_top:
    s_cmp_ge_u32 s42, s43
    s_cbranch_scc1 L_w109_evt
L_w109_go:
    s_and_b32 m0, s48, 0x1ffff
    s_waitcnt vmcnt(26)
    buffer_load_dwordx4 v8, s[24:27], s21 offen nt lds
    s_add_u32 s42, s42, 1
    s_waitcnt vmcnt(26)
    buffer_load_dwordx4 v9, s[24:27], s21 offen offset:1024 nt lds
    s_add_u32 s48, s48, 0x2000
    s_waitcnt vmcnt(26)
    ds_add_u32 v5, v19
    buffer_load_dwordx4 v10, s[24:27], s21 offen offset:2048 nt lds
    ds_read_b32 v21, v22
    s_waitcnt vmcnt(27)
    buffer_load_dwordx4 v11, s[24:27], s21 offen offset:3072 nt lds
    s_and_b32 m0, s59, 0x1ffff
    s_waitcnt vmcnt(26)
    buffer_load_dwordx4 v12, s[28:31], s58 offen nt lds
    v_readlane_b32 s21, v16, s42
    s_waitcnt vmcnt(26)
    buffer_load_dwordx4 v13, s[28:31], s58 offen offset:1024 nt lds
    s_add_u32 s59, s59, 0x2000
    s_waitcnt vmcnt(26)
    ds_add_u32 v5, v19
    buffer_load_dwordx4 v14, s[28:31], s58 offen offset:2048 nt lds
    s_waitcnt vmcnt(27)
    buffer_load_dwordx4 v15, s[28:31], s58 offen offset:3072 nt lds
    v_readlane_b32 s58, v28, s42
    s_branch L_w109_top
L_w109_evt:
    s_cmp_eq_u32 s42, s44
    s_cbranch_scc1 L_rare
L_w109_slow:
    s_waitcnt lgkmcnt(0)
    v_readlane_b32 s60, v21, 0
    v_readlane_b32 s61, v21, 1
    v_readlane_b32 s62, v21, 2
    v_readlane_b32 s63, v21, 3
    ds_read_b32 v21, v22
    s_min_u32 s60, s60, s61
    s_min_u32 s62, s62, s63
    s_min_u32 s47, s60, s62
    s_add_u32 s47, s47, 16
    s_min_u32 s43, s44, s47
    s_cmp_lt_u32 s42, s47
    s_cbranch_scc1 L_w109_go
    s_branch L_w109_slow
L_w110:
    v_mov_b32 v6, s54
    v_add_u32 v6, -10, v6
    s_waitcnt vmcnt(28)
    ds_write_b32 v5, v6
    s_branch L_w110_evt
L_w110_top:
    s_cmp_ge_u32 s42, s43
    s_cbranch_scc1 L_w110_evt
L_w110_go:
    s_and_b32 m0, s48, 0x1ffff
    s_waitcnt vmcnt(26)
    buffer_load_dwordx4 v8, s[24:27], s21 offen nt lds
    s_add_u32 s42, s42, 1
    s_waitcnt vmcnt(27)
    buffer_load_dwordx4 v9, s[24:27], s21 offen offset:1024 nt lds
    s_add_u32 s48, s48, 0x2000
    s_waitcnt vmcnt(26)
    ds_add_u32 v5, v19
    buffer_load_dwordx4 v10, s[24:27], s21 offen offset:2048 nt lds
    ds_read_b32 v21, v22
    s_waitcnt vmcnt(27)
    buffer_load_dwordx4 v11, s[24:27], s21 offen offset:3072 nt lds
    s_and_b32 m0, s59, 0x1ffff
    s_waitcnt vmcnt(26)
    buffer_load_dwordx4 v12, s[28:31], s58 offen nt lds
    v_readlane_b32 s21, v16, s42
    s_waitcnt vmcnt(27)
    buffer_load_dwordx4 v13, s[28:31], s58 offen offset:1024 nt lds
    s_add_u32 s59, s59, 0x2000
    s_waitcnt vmcnt(26)
    ds_add_u32 v5, v19
    buffer_load_dwordx4 v14, s[28:31], s58 offen offset:2048 nt lds
    s_waitcnt vmcnt(27)
    buffer_load_dwordx4 v15, s[28:31], s58 offen offset:3072 nt lds
    v_readlane_b32 s58, v28, s42
    s_branch L_w110_top
L_w110_evt:
    s_cmp_eq_u32 s42, s44
    s_cbranch_scc1 L_rare
L_w110_slow:
    s_waitcnt lgkmcnt(0)
    v_readlane_b32 s60, v21, 0
    v_readlane_b32 s61, v21, 1
    v_readlane_b32 s62, v21, 2
    v_readlane_b32 s63, v21, 3
    ds_read_b32 v21, v22
    s_min_u32 s60, s60, s61
    s_min_u32 s62, s62, s63
    s_min_u32 s47, s60, s62
    s_add_u32 s47, s47, 16
    s_min_u32 s43, s44, s47
    s_cmp_lt_u32 s42, s47
    s_cbranch_scc1 L_w110_go
    s_branch L_w110_slow
L_w111:
    v_mov_b32 v6, s54
    v_add_u32 v6, -10, v6
    s_waitcnt vmcnt(28)
    ds_write_b32 v5, v6
    s_branch L_w111_evt
L_w111_top:
    s_cmp_ge_u32 s42, s43
    s_cbranch_scc1 L_w111_evt
L_w111_go:
    s_and_b32 m0, s48, 0x1ffff
    s_waitcnt vmcnt(26)
    buffer_load_dwordx4 v8, s[24:27], s21 offen nt lds
    s_add_u32 s42, s42, 1
    s_waitcnt vmcnt(27)
    buffer_load_dwordx4 v9, s[24:27], s21 offen offset:1024 nt lds
    s_add_u32 s48, s48, 0x2000
    s_waitcnt vmcnt(27)
    buffer_load_dwordx4 v10, s[24:27], s21 offen offset:2048 nt lds
    ds_read_b32 v21, v22
    s_waitcnt vmcnt(27)
    ds_add_u32 v5, v19
    buffer_load_dwordx4 v11, s[24:27], s21 offen offset:3072 nt lds
    s_and_b32 m0, s59, 0x1ffff
    s_waitcnt vmcnt(26)
    buffer_load_dwordx4 v12, s[28:31], s58 offen nt lds
    v_readlane_b32 s21, v16, s42
    s_waitcnt vmcnt(27)
    buffer_load_dwordx4 v13, s[28:31], s58 offen offset:1024 nt lds
    s_add_u32 s59, s59, 0x2000
    s_waitcnt vmcnt(27)
    buffer_load_dwordx4 v14, s[28:31], s58 offen offset:2048 nt lds
    s_waitcnt vmcnt(27)
    ds_add_u32 v5, v19
    buffer_load_dwordx4 v15, s[28:31], s58 offen offset:3072 nt lds
    v_readlane_b32 s58, v28, s42
    s_branch L_w111_top
L_w111_evt:
    s_cmp_eq_u32 s42, s44
    s_cbranch_scc1 L_rare
L_w111_slow:
    s_waitcnt lgkmcnt(0)
    v_readlane_b32 s60, v21, 0
    v_readlane_b32 s61, v21, 1
    v_readlane_b32 s62, v21, 2
    v_readlane_b32 s63, v21, 3
    ds_read_b32 v21, v22
    s_min_u32 s60, s60, s61
    s_min_u32 s62, s62, s63
    s_min_u32 s47, s60, s62
    s_add_u32 s47, s47, 16
    s_min_u32 s43, s44, s47
    s_cmp_lt_u32 s42, s47
    s_cbranch_scc1 L_w111_go
    s_branch L_w111_slow
L_w112:
    v_mov_b32 v6, s54
    v_add_u32 v6, -10, v6
    s_waitcnt vmcnt(28)
    ds_write_b32 v5, v6
    s_branch L_w112_evt
L_w112_top:
    s_cmp_ge_u32 s42, s43
    s_cbranch_scc1 L_w112_evt
L_w112_go:
    s_and_b32 m0, s48, 0x1ffff
    s_waitcnt vmcnt(27)
    buffer_load_dwordx4 v8, s[24:27], s21 offen nt lds
    s_add_u32 s42, s42, 1
    s_waitcnt vmcnt(27)
    buffer_load_dwordx4 v9, s[24:27], s21 offen offset:1024 nt lds
    s_add_u32 s48, s48, 0x2000
    s_waitcnt vmcnt(27)
    buffer_load_dwordx4 v10, s[24:27], s21 offen offset:2048 nt lds
    ds_read_b32 v21, v22
    s_waitcnt vmcnt(27)
    ds_add_u32 v5, v19
    buffer_load_dwordx4 v11, s[24:27], s21 offen offset:3072 nt lds
    s_and_b32 m0, s59, 0x1ffff
    s_waitcnt vmcnt(27)
    buffer_load_dwordx4 v12, s[28:31], s58 offen nt lds
    v_readlane_b32 s21, v16, s42
    s_waitcnt vmcnt(27)
    buffer_load_dwordx4 v13, s[28:31], s58 offen offset:1024 nt lds
    s_add_u32 s59, s59, 0x2000
    s_waitcnt vmcnt(27)
    buffer_load_dwordx4 v14, s[28:31], s58 offen offset:2048 nt lds
    s_waitcnt vmcnt(27)
    ds_add_u32 v5, v19
    buffer_load_dwordx4 v15, s[28:31], s58 offen offset:3072 nt lds
    v_readlane_b32 s58, v28, s42
    s_branch L_w112_top
L_w112_evt:
    s_cmp_eq_u32 s42, s44
    s_cbranch_scc1 L_rare
L_w112_slow:
    s_waitcnt lgkmcnt(0)
    v_readlane_b32 s60, v21, 0
    v_readlane_b32 s61, v21, 1
    v_readlane_b32 s62, v21, 2
    v_readlane_b32 s63, v21, 3
    ds_read_b32 v21, v22
    s_min_u32 s60, s60, s61
    s_min_u32 s62, s62, s63
    s_min_u32 s47, s60, s62
    s_add_u32 s47, s47, 16
    s_min_u32 s43, s44, s47
    s_cmp_lt_u32 s42, s47
    s_cbranch_scc1 L_w112_go
    s_branch L_w112_slow
L_w113:
    v_mov_b32 v6, s54
    v_add_u32 v6, -11, v6
    s_waitcnt vmcnt(32)
    ds_write_b32 v5, v6
    s_branch L_w113_evt
L_w113_top:
    s_cmp_ge_u32 s42, s43
    s_cbranch_scc1 L_w113_evt
L_w113_go:
    s_and_b32 m0, s48, 0x1ffff
    s_waitcnt vmcnt(27)
    ds_add_u32 v5, v19
    buffer_load_dwordx4 v8, s[24:27], s21 offen nt lds
    s_add_u32 s42, s42, 1
    s_waitcnt vmcnt(27)
    buffer_load_dwordx4 v9, s[24:27], s21 offen offset:1024 nt lds
    s_add_u32 s48, s48, 0x2000
    s_waitcnt vmcnt(27)
    buffer_load_dwordx4 v10, s[24:27], s21 offen offset:2048 nt lds
    ds_read_b32 v21, v22
    s_waitcnt vmcnt(28)
    buffer_load_dwordx4 v11, s[24:27], s21 offen offset:3072 nt lds
    s_and_b32 m0, s59, 0x1ffff
    s_waitcnt vmcnt(27)
    ds_add_u32 v5, v19
    buffer_load_dwordx4 v12, s[28:31], s58 offen nt lds
    v_readlane_b32 s21, v16, s42
    s_waitcnt vmcnt(27)
    buffer_load_dwordx4 v13, s[28:31], s58 offen offset:1024 nt lds
    s_add_u32 s59, s59, 0x2000
    s_waitcnt vmcnt(27)
    buffer_load_dwordx4 v14, s[28:31], s58 offen offset:2048 nt lds
    s_waitcnt vmcnt(28)
    buffer_load_dwordx4 v15, s[28:31], s58 offen offset:3072 nt lds
    v_readlane_b32 s58, v28, s42
    s_branch L_w113_top
L_w113_evt:
    s_cmp_eq_u32 s42, s44
    s_cbranch_scc1 L_rare
L_w113_slow:
    s_waitcnt lgkmcnt(0)
    v_readlane_b32 s60, v21, 0
    v_readlane_b32 s61, v21, 1
    v_readlane_b32 s62, v21, 2
    v_readlane_b32 s63, v21, 3
    ds_read_b32 v21, v22
    s_min_u32 s60, s60, s61
    s_min_u32 s62, s62, s63
    s_min_u32 s47, s60, s62
    s_add_u32 s47, s47, 16
    s_min_u32 s43, s44, s47
    s_cmp_lt_u32 s42, s47
    s_cbranch_scc1 L_w113_go
    s_branch L_w113_slow
L_w114:
    v_mov_b32 v6, s54
    v_add_u32 v6, -11, v6
    s_waitcnt vmcnt(32)
    ds_write_b32 v5, v6
    s_branch L_w114_evt
L_w114_top:
    s_cmp_ge_u32 s42, s43
    s_cbranch_scc1 L_w114_evt
L_w114_go:
    s_and_b32 m0, s48, 0x1ffff
    s_waitcnt vmcnt(27)
    ds_add_u32 v5, v19
    buffer_load_dwordx4 v8, s[24:27], s21 offen nt lds
    s_add_u32 s42, s42, 1
    s_waitcnt vmcnt(28)
    buffer_load_dwordx4 v9, s[24:27], s21 offen offset:1024 nt lds
    s_add_u32 s48, s48, 0x2000
    s_waitcnt vmcnt(27)
    buffer_load_dwordx4 v10, s[24:27], s21 offen offset:2048 nt lds
    ds_read_b32 v21, v22
    s_waitcnt vmcnt(28)
    buffer_load_dwordx4 v11, s[24:27], s21 offen offset:3072 nt lds
    s_and_b32 m0, s59, 0x1ffff
    s_waitcnt vmcnt(27)
    ds_add_u32 v5, v19
    buffer_load_dwordx4 v12, s[28:31], s58 offen nt lds
    v_readlane_b32 s21, v16, s42
    s_waitcnt vmcnt(28)
    buffer_load_dwordx4 v13, s[28:31], s58 offen offset:1024 nt lds
    s_add_u32 s59, s59, 0x2000
    s_waitcnt vmcnt(27)
    buffer_load_dwordx4 v14, s[28:31], s58 offen offset:2048 nt lds
    s_waitcnt vmcnt(28)
    buffer_load_dwordx4 v15, s[28:31], s58 offen offset:3072 nt lds
    v_readlane_b32 s58, v28, s42
    s_branch L_w114_top
L_w114_evt:
    s_cmp_eq_u32 s42, s44
    s_cbranch_scc1 L_rare
L_w114_slow:
    s_waitcnt lgkmcnt(0)
    v_readlane_b32 s60, v21, 0
    v_readlane_b32 s61, v21, 1
    v_readlane_b32 s62, v21, 2
    v_readlane_b32 s63, v21, 3
    ds_read_b32 v21, v22
    s_min_u32 s60, s60, s61
    s_min_u32 s62, s62, s63
    s_min_u32 s47, s60, s62
    s_add_u32 s47, s47, 16
    s_min_u32 s43, s44, s47
    s_cmp_lt_u32 s42, s47
    s_cbranch_scc1 L_w114_go
    s_branch L_w114_slow
L_w115:
    v_mov_b32 v6, s54
    v_add_u32 v6, -11, v6
    s_waitcnt vmcnt(32)
    ds_write_b32 v5, v6
    s_branch L_w115_evt
L_w115_top:
    s_cmp_ge_u32 s42, s43
    s_cbranch_scc1 L_w115_evt
L_w115_go:
    s_and_b32 m0, s48, 0x1ffff
    s_waitcnt vmcnt(27)
    ds_add_u32 v5, v19
    buffer_load_dwordx4 v8, s[24:27], s21 offen nt lds
    s_add_u32 s42, s42, 1
    s_waitcnt vmcnt(28)
    buffer_load_dwordx4 v9, s[24:27], s21 offen offset:1024 nt lds
    s_add_u32 s48, s48, 0x2000
    s_waitcnt vmcnt(28)
    buffer_load_dwordx4 v10, s[24:27], s21 offen offset:2048 nt lds
    ds_read_b32 v21, v22
    s_waitcnt vmcnt(28)
    buffer_load_dwordx4 v11, s[24:27], s21 offen offset:3072 nt lds
    s_and_b32 m0, s59, 0x1ffff
    s_waitcnt vmcnt(27)
    ds_add_u32 v5, v19
    buffer_load_dwordx4 v12, s[28:31], s58 offen nt lds
    v_readlane_b32 s21, v16, s42
    s_waitcnt vmcnt(28)
    buffer_load_dwordx4 v13, s[28:31], s58 offen offset:1024 nt lds
    s_add_u32 s59, s59, 0x2000
    s_waitcnt vmcnt(28)
    buffer_load_dwordx4 v14, s[28:31], s58 offen offset:2048 nt lds
    s_waitcnt vmcnt(28)
    buffer_load_dwordx4 v15, s[28:31], s58 offen offset:3072 nt lds
    v_readlane_b32 s58, v28, s42
    s_branch L_w115_top
L_w115_evt:
    s_cmp_eq_u32 s42, s44
    s_cbranch_scc1 L_rare
L_w115_slow:
    s_waitcnt lgkmcnt(0)
    v_readlane_b32 s60, v21, 0
    v_readlane_b32 s61, v21, 1
    v_readlane_b32 s62, v21, 2
    v_readlane_b32 s63, v21, 3
    ds_read_b32 v21, v22
    s_min_u32 s60, s60, s61
    s_min_u32 s62, s62, s63
    s_min_u32 s47, s60, s62
    s_add_u32 s47, s47, 16
    s_min_u32 s43, s44, s47
    s_cmp_lt_u32 s42, s47
    s_cbranch_scc1 L_w115_go
    s_branch L_w115_slow
L_w116:
    v_mov_b32 v6, s54
    v_add_u32 v6, -11, v6
    s_waitcnt vmcnt(32)
    ds_write_b32 v5, v6
    s_branch L_w116_evt
L_w116_top:
    s_cmp_ge_u32 s42, s43
    s_cbranch_scc1 L_w116_evt
L_w116_go:
    s_and_b32 m0, s48, 0x1ffff
    s_waitcnt vmcnt(28)
    ds_add_u32 v5, v19
    buffer_load_dwordx4 v8, s[24:27], s21 offen nt lds
    s_add_u32 s42, s42, 1
    s_waitcnt vmcnt(28)
    buffer_load_dwordx4 v9, s[24:27], s21 offen offset:1024 nt lds
    s_add_u32 s48, s48, 0x2000
    s_waitcnt vmcnt(28)
    buffer_load_dwordx4 v10, s[24:27], s21 offen offset:2048 nt lds
    ds_read_b32 v21, v22
    s_waitcnt vmcnt(28)
    buffer_load_dwordx4 v11, s[24:27], s21 offen offset:3072 nt lds
    s_and_b32 m0, s59, 0x1ffff
    s_waitcnt vmcnt(28)
    ds_add_u32 v5, v19
    buffer_load_dwordx4 v12, s[28:31], s58 offen nt lds
    v_readlane_b32 s21, v16, s42
    s_waitcnt vmcnt(28)
    buffer_load_dwordx4 v13, s[28:31], s58 offen offset:1024 nt lds
    s_add_u32 s59, s59, 0x2000
    s_waitcnt vmcnt(28)
    buffer_load_dwordx4 v14, s[28:31], s58 offen offset:2048 nt lds
    s_waitcnt vmcnt(28)
    buffer_load_dwordx4 v15, s[28:31], s58 offen offset:3072 nt lds
    v_readlane_b32 s58, v28, s42
    s_branch L_w116_top
L_w116_evt:
    s_cmp_eq_u32 s42, s44
    s_cbranch_scc1 L_rare
L_w116_slow:
    s_waitcnt lgkmcnt(0)
    v_readlane_b32 s60, v21, 0
    v_readlane_b32 s61, v21, 1
    v_readlane_b32 s62, v21, 2
    v_readlane_b32 s63, v21, 3
    ds_read_b32 v21, v22
    s_min_u32 s60, s60, s61
    s_min_u32 s62, s62, s63
    s_min_u32 s47, s60, s62
    s_add_u32 s47, s47, 16
    s_min_u32 s43, s44, s47
    s_cmp_lt_u32 s42, s47
    s_cbranch_scc1 L_w116_go
    s_branch L_w116_slow
L_w117:
    v_mov_b32 v6, s54
    v_add_u32 v6, -11, v6
    s_waitcnt vmcnt(32)
    ds_write_b32 v5, v6
    s_branch L_w117_evt
L_w117_top:
    s_cmp_ge_u32 s42, s43
    s_cbranch_scc1 L_w117_evt
L_w117_go:
    s_and_b32 m0, s48, 0x1ffff
    s_waitcnt vmcnt(28)
    ds_add_u32 v5, v19
    buffer_load_dwordx4 v8, s[24:27], s21 offen nt lds
    s_add_u32 s42, s42, 1
    s_waitcnt vmcnt(28)
    buffer_load_dwordx4 v9, s[24:27], s21 offen offset:1024 nt lds
    s_add_u32 s48, s48, 0x2000
    s_waitcnt vmcnt(28)
    buffer_load_dwordx4 v10, s[24:27], s21 offen offset:2048 nt lds
    ds_read_b32 v21, v22
    s_waitcnt vmcnt(29)
    buffer_load_dwordx4 v11, s[24:27], s21 offen offset:3072 nt lds
    s_and_b32 m0, s59, 0x1ffff
    s_waitcnt vmcnt(28)
    ds_add_u32 v5, v19
    buffer_load_dwordx4 v12, s[28:31], s58 offen nt lds
    v_readlane_b32 s21, v16, s42
    s_waitcnt vmcnt(28)
    buffer_load_dwordx4 v13, s[28:31], s58 offen offset:1024 nt lds
    s_add_u32 s59, s59, 0x2000
    s_waitcnt vmcnt(28)
    buffer_load_dwordx4 v14, s[28:31], s58 offen offset:2048 nt lds
    s_waitcnt vmcnt(29)
    buffer_load_dwordx4 v15, s[28:31], s58 offen offset:3072 nt lds
    v_readlane_b32 s58, v28, s42
    s_branch L_w117_top
L_w117_evt:
    s_cmp_eq_u32 s42, s44
    s_cbranch_scc1 L_rare
L_w117_slow:
    s_waitcnt lgkmcnt(0)
    v_readlane_b32 s60, v21, 0
    v_readlane_b32 s61, v21, 1
    v_readlane_b32 s62, v21, 2
    v_readlane_b32 s63, v21, 3
    ds_read_b32 v21, v22
    s_min_u32 s60, s60, s61
    s_min_u32 s62, s62, s63
    s_min_u32 s47, s60, s62
    s_add_u32 s47, s47, 16
    s_min_u32 s43, s44, s47
    s_cmp_lt_u32 s42, s47
    s_cbranch_scc1 L_w117_go
    s_branch L_w117_slow
L_w118:
    v_mov_b32 v6, s54
    v_add_u32 v6, -11, v6
    s_waitcnt vmcnt(32)
    ds_write_b32 v5, v6
    s_branch L_w118_evt
L_w118_top:
    s_cmp_ge_u32 s42, s43
    s_cbranch_scc1 L_w118_evt
L_w118_go:
    s_and_b32 m0, s48, 0x1ffff
    s_waitcnt vmcnt(28)
    ds_add_u32 v5, v19
    buffer_load_dwordx4 v8, s[24:27], s21 offen nt lds
    s_add_u32 s42, s42, 1
    s_waitcnt vmcnt(29)
    buffer_load_dwordx4 v9, s[24:27], s21 offen offset:1024 nt lds
    s_add_u32 s48, s48, 0x2000
    s_waitcnt vmcnt(28)
    buffer_load_dwordx4 v10, s[24:27], s21 offen offset:2048 nt lds
    ds_read_b32 v21, v22
    s_waitcnt vmcnt(29)
    buffer_load_dwordx4 v11, s[24:27], s21 offen offset:3072 nt lds
    s_and_b32 m0, s59, 0x1ffff
    s_waitcnt vmcnt(28)
    ds_add_u32 v5, v19
    buffer_load_dwordx4 v12, s[28:31], s58 offen nt lds
    v_readlane_b32 s21, v16, s42
    s_waitcnt vmcnt(29)
    buffer_load_dwordx4 v13, s[28:31], s58 offen offset:1024 nt lds
    s_add_u32 s59, s59, 0x2000
    s_waitcnt vmcnt(28)
    buffer_load_dwordx4 v14, s[28:31], s58 offen offset:2048 nt lds
    s_waitcnt vmcnt(29)
    buffer_load_dwordx4 v15, s[28:31], s58 offen offset:3072 nt lds
    v_readlane_b32 s58, v28, s42
    s_branch L_w118_top
L_w118_evt:
    s_cmp_eq_u32 s42, s44
    s_cbranch_scc1 L_rare
L_w118_slow:
    s_waitcnt lgkmcnt(0)
    v_readlane_b32 s60, v21, 0
    v_readlane_b32 s61, v21, 1
    v_readlane_b32 s62, v21, 2
    v_readlane_b32 s63, v21, 3
    ds_read_b32 v21, v22
    s_min_u32 s60, s60, s61
    s_min_u32 s62, s62, s63
    s_min_u32 s47, s60, s62
    s_add_u32 s47, s47, 16
    s_min_u32 s43, s44, s47
    s_cmp_lt_u32 s42, s47
    s_cbranch_scc1 L_w118_go
    s_branch L_w118_slow
L_w119:
    v_mov_b32 v6, s54
    v_add_u32 v6, -11, v6
    s_waitcnt vmcnt(32)
    ds_write_b32 v5, v6
    s_branch L_w119_evt
L_w119_top:
    s_cmp_ge_u32 s42, s43
    s_cbranch_scc1 L_w119_evt
L_w119_go:
    s_and_b32 m0, s48, 0x1ffff
    s_waitcnt vmcnt(28)
    ds_add_u32 v5, v19
    buffer_load_dwordx4 v8, s[24:27], s21 offen nt lds
    s_add_u32 s42, s42, 1
    s_waitcnt vmcnt(29)
    buffer_load_dwordx4 v9, s[24:27], s21 offen offset:1024 nt lds
    s_add_u32 s48, s48, 0x2000
    s_waitcnt vmcnt(29)
    buffer_load_dwordx4 v10, s[24:27], s21 offen offset:2048 nt lds
    ds_read_b32 v21, v22
    s_waitcnt vmcnt(29)
    buffer_load_dwordx4 v11, s[24:27], s21 offen offset:3072 nt lds
    s_and_b32 m0, s59, 0x1ffff
    s_waitcnt vmcnt(28)
    ds_add_u32 v5, v19
    buffer_load_dwordx4 v12, s[28:31], s58 offen nt lds
    v_readlane_b32 s21, v16, s42
    s_waitcnt vmcnt(29)
    buffer_load_dwordx4 v13, s[28:31], s58 offen offset:1024 nt lds
    s_add_u32 s59, s59, 0x2000
    s_waitcnt vmcnt(29)
    buffer_load_dwordx4 v14, s[28:31], s58 offen offset:2048 nt lds
    s_waitcnt vmcnt(29)
    buffer_load_dwordx4 v15, s[28:31], s58 offen offset:3072 nt lds
    v_readlane_b32 s58, v28, s42
    s_branch L_w119_top
L_w119_evt:
    s_cmp_eq_u32 s42, s44
    s_cbranch_scc1 L_rare
L_w119_slow:
    s_waitcnt lgkmcnt(0)
    v_readlane_b32 s60, v21, 0
    v_readlane_b32 s61, v21, 1
    v_readlane_b32 s62, v21, 2
    v_readlane_b32 s63, v21, 3
    ds_read_b32 v21, v22
    s_min_u32 s60, s60, s61
    s_min_u32 s62, s62, s63
    s_min_u32 s47, s60, s62
    s_add_u32 s47, s47, 16
    s_min_u32 s43, s44, s47
    s_cmp_lt_u32 s42, s47
    s_cbranch_scc1 L_w119_go
    s_branch L_w119_slow
L_w120:
    v_mov_b32 v6, s54
    v_add_u32 v6, -11, v6
    s_waitcnt vmcnt(32)
    ds_write_b32 v5, v6
    s_branch L_w120_evt
L_w120_top:
    s_cmp_ge_u32 s42, s43
    s_cbranch_scc1 L_w120_evt
L_w120_go:
    s_and_b32 m0, s48, 0x1ffff
    s_waitcnt vmcnt(29)
    buffer_load_dwordx4 v8, s[24:27], s21 offen nt lds
    s_add_u32 s42, s42, 1
    s_waitcnt vmcnt(29)
    ds_add_u32 v5, v19
    buffer_load_dwordx4 v9, s[24:27], s21 offen offset:1024 nt lds
    s_add_u32 s48, s48, 0x2000
    s_waitcnt vmcnt(29)
    buffer_load_dwordx4 v10, s[24:27], s21 offen offset:2048 nt lds
    ds_read_b32 v21, v22
    s_waitcnt vmcnt(29)
    buffer_load_dwordx4 v11, s[24:27], s21 offen offset:3072 nt lds
    s_and_b32 m0, s59, 0x1ffff
    s_waitcnt vmcnt(29)
    buffer_load_dwordx4 v12, s[28:31], s58 offen nt lds
    v_readlane_b32 s21, v16, s42
    s_waitcnt vmcnt(29)
    ds_add_u32 v5, v19
    buffer_load_dwordx4 v13, s[28:31], s58 offen offset:1024 nt lds
    s_add_u32 s59, s59, 0x2000
    s_waitcnt vmcnt(29)
    buffer_load_dwordx4 v14, s[28:31], s58 offen offset:2048 nt lds
    s_waitcnt vmcnt(29)
    buffer_load_dwordx4 v15, s[28:31], s58 offen offset:3072 nt lds
    v_readlane_b32 s58, v28, s42
    s_branch L_w120_top
L_w120_evt:
    s_cmp_eq_u32 s42, s44
    s_cbranch_scc1 L_rare
L_w120_slow:
    s_waitcnt lgkmcnt(0)
    v_readlane_b32 s60, v21, 0
    v_readlane_b32 s61, v21, 1
    v_readlane_b32 s62, v21, 2
    v_readlane_b32 s63, v21, 3
    ds_read_b32 v21, v22
    s_min_u32 s60, s60, s61
    s_min_u32 s62, s62, s63
    s_min_u32 s47, s60, s62
    s_add_u32 s47, s47, 16
    s_min_u32 s43, s44, s47
    s_cmp_lt_u32 s42, s47
    s_cbranch_scc1 L_w120_go
    s_branch L_w120_slow
L_tail:
    s_sub_u32 s53, s42, 3
    s_sub_u32 s54, s41, s22
    s_add_u32 s54, s54, s53
    v_mov_b32 v7, s54
L_tail_next:
    s_cmp_ge_u32 s53, 64
    v_readlane_b32 s60, v31, s53
    v_readlane_b32 s61, v17, s53
    s_cselect_b32 s58, s61, s60
    s_add_u32 s53, s53, 1
    s_cmp_lt_u32 s53, s22
    s_cbranch_scc1 L_tail_go
    s_and_b32 s57, s56, 15
    v_mov_b32 v6, 0x7fff0000
    v_cmp_ge_i32 s[64:65], s57, v2
    s_sub_u32 s57, s57, 4
    v_cmp_ge_i32 s[66:67], s57, v2
    s_sub_u32 s57, s57, 4
    v_cmp_ge_i32 s[68:69], s57, v2
    s_sub_u32 s57, s57, 4
    v_cmp_ge_i32 s[70:71], s57, v2
    s_sub_u32 s57, s57, 4
    s_nop 0
    v_cndmask_b32 v12, v6, v12, s[64:65]
    v_cndmask_b32 v13, v6, v13, s[66:67]
    v_cndmask_b32 v14, v6, v14, s[68:69]
    v_cndmask_b32 v15, v6, v15, s[70:71]
L_tail_go:
    s_and_b32 m0, s59, 0x1ffff
    s_add_u32 s59, s59, 0x2000
    s_cmp_gt_u32 s40, 75
    s_cbranch_scc1 L_disp193
    s_cmp_gt_u32 s40, 51
    s_cbranch_scc1 L_disp194
    s_cmp_gt_u32 s40, 39
    s_cbranch_scc1 L_disp195
    s_cmp_gt_u32 s40, 31
    s_cbranch_scc1 L_disp196
    s_cmp_gt_u32 s40, 27
    s_cbranch_scc1 L_disp197
    s_branch L_tail6
L_disp197:
    s_branch L_tail7
L_disp196:
    s_cmp_gt_u32 s40, 35
    s_cbranch_scc1 L_disp198
    s_branch L_tail8
L_disp198:
    s_branch L_tail9
L_disp195:
    s_cmp_gt_u32 s40, 47
    s_cbranch_scc1 L_disp199
    s_cmp_gt_u32 s40, 43
    s_cbranch_scc1 L_disp200
    s_branch L_tail10
L_disp200:
    s_branch L_tail11
L_disp199:
    s_branch L_tail12
L_disp194:
    s_cmp_gt_u32 s40, 63
    s_cbranch_scc1 L_disp201
    s_cmp_gt_u32 s40, 59
    s_cbranch_scc1 L_disp202
    s_cmp_gt_u32 s40, 55
    s_cbranch_scc1 L_disp203
    s_branch L_tail13
L_disp203:
    s_branch L_tail14
L_disp202:
    s_branch L_tail15
L_disp201:
    s_cmp_gt_u32 s40, 71
    s_cbranch_scc1 L_disp204
    s_cmp_gt_u32 s40, 67
    s_cbranch_scc1 L_disp205
    s_branch L_tail16
L_disp205:
    s_branch L_tail17
L_disp204:
    s_branch L_tail18
L_disp193:
    s_cmp_gt_u32 s40, 99
    s_cbranch_scc1 L_disp206
    s_cmp_gt_u32 s40, 87
    s_cbranch_scc1 L_disp207
    s_cmp_gt_u32 s40, 83
    s_cbranch_scc1 L_disp208
    s_cmp_gt_u32 s40, 79
    s_cbranch_scc1 L_disp209
    s_branch L_tail19
L_disp209:
    s_branch L_tail20
L_disp208:
    s_branch L_tail21
L_disp207:
    s_cmp_gt_u32 s40, 95
    s_cbranch_scc1 L_disp210
    s_cmp_gt_u32 s40, 91
    s_cbranch_scc1 L_disp211
    s_branch L_tail22
L_disp211:
    s_branch L_tail23
L_disp210:
    s_branch L_tail24
L_disp206:
    s_cmp_gt_u32 s40, 111
    s_cbranch_scc1 L_disp212
    s_cmp_gt_u32 s40, 107
    s_cbranch_scc1 L_disp213
    s_cmp_gt_u32 s40, 103
    s_cbranch_scc1 L_disp214
    s_branch L_tail25
L_disp214:
    s_branch L_tail26
L_disp213:
    s_branch L_tail27
L_disp212:
    s_cmp_gt_u32 s40, 119
    s_cbranch_scc1 L_disp215
    s_cmp_gt_u32 s40, 115
    s_cbranch_scc1 L_disp216
    s_branch L_tail28
L_disp216:
    s_branch L_tail29
L_disp215:
    s_branch L_tail30
L_tail6:
    s_waitcnt vmcnt(5)
    buffer_load_dwordx4 v12, s[28:31], s58 offen nt lds
    s_waitcnt vmcnt(5)
    v_add_u32 v6, -1, v7
    ds_max_i32 v5, v6
    buffer_load_dwordx4 v13, s[28:31], s58 offen offset:1024 nt lds
    s_waitcnt vmcnt(5)
    buffer_load_dwordx4 v14, s[28:31], s58 offen offset:2048 nt lds
    s_waitcnt vmcnt(5)
    buffer_load_dwordx4 v15, s[28:31], s58 offen offset:3072 nt lds
    s_branch L_tail_end
L_tail7:
    s_waitcnt vmcnt(6)
    buffer_load_dwordx4 v12, s[28:31], s58 offen nt lds
    s_waitcnt vmcnt(6)
    buffer_load_dwordx4 v13, s[28:31], s58 offen offset:1024 nt lds
    s_waitcnt vmcnt(6)
    v_add_u32 v6, -1, v7
    ds_max_i32 v5, v6
    buffer_load_dwordx4 v14, s[28:31], s58 offen offset:2048 nt lds
    s_waitcnt vmcnt(6)
    buffer_load_dwordx4 v15, s[28:31], s58 offen offset:3072 nt lds
    s_branch L_tail_end
L_tail8:
    s_waitcnt vmcnt(7)
    buffer_load_dwordx4 v12, s[28:31], s58 offen nt lds
    s_waitcnt vmcnt(7)
    buffer_load_dwordx4 v13, s[28:31], s58 offen offset:1024 nt lds
    s_waitcnt vmcnt(7)
    buffer_load_dwordx4 v14, s[28:31], s58 offen offset:2048 nt lds
    s_waitcnt vmcnt(7)
    v_add_u32 v6, -1, v7
    ds_max_i32 v5, v6
    buffer_load_dwordx4 v15, s[28:31], s58 offen offset:3072 nt lds
    s_branch L_tail_end
L_tail9:
    s_waitcnt vmcnt(8)
    v_add_u32 v6, -2, v7
    ds_max_i32 v5, v6
    buffer_load_dwordx4 v12, s[28:31], s58 offen nt lds
    s_waitcnt vmcnt(8)
    buffer_load_dwordx4 v13, s[28:31], s58 offen offset:1024 nt lds
    s_waitcnt vmcnt(8)
    buffer_load_dwordx4 v14, s[28:31], s58 offen offset:2048 nt lds
    s_waitcnt vmcnt(8)
    buffer_load_dwordx4 v15, s[28:31], s58 offen offset:3072 nt lds
    s_branch L_tail_end
L_tail10:
    s_waitcnt vmcnt(9)
    buffer_load_dwordx4 v12, s[28:31], s58 offen nt lds
    s_waitcnt vmcnt(9)
    v_add_u32 v6, -2, v7
    ds_max_i32 v5, v6
    buffer_load_dwordx4 v13, s[28:31], s58 offen offset:1024 nt lds
    s_waitcnt vmcnt(9)
    buffer_load_dwordx4 v14, s[28:31], s58 offen offset:2048 nt lds
    s_waitcnt vmcnt(9)
    buffer_load_dwordx4 v15, s[28:31], s58 offen offset:3072 nt lds
    s_branch L_tail_end
L_tail11:
    s_waitcnt vmcnt(10)
    buffer_load_dwordx4 v12, s[28:31], s58 offen nt lds
    s_waitcnt vmcnt(10)
    buffer_load_dwordx4 v13, s[28:31], s58 offen offset:1024 nt lds
    s_waitcnt vmcnt(10)
    v_add_u32 v6, -2, v7
    ds_max_i32 v5, v6
    buffer_load_dwordx4 v14, s[28:31], s58 offen offset:2048 nt lds
    s_waitcnt vmcnt(10)
    buffer_load_dwordx4 v15, s[28:31], s58 offen offset:3072 nt lds
    s_branch L_tail_end
L_tail12:
    s_waitcnt vmcnt(11)
    buffer_load_dwordx4 v12, s[28:31], s58 offen nt lds
    s_waitcnt vmcnt(11)
    buffer_load_dwordx4 v13, s[28:31], s58 offen offset:1024 nt lds
    s_waitcnt vmcnt(11)
    buffer_load_dwordx4 v14, s[28:31], s58 offen offset:2048 nt lds
    s_waitcnt vmcnt(11)
    v_add_u32 v6, -2, v7
    ds_max_i32 v5, v6
    buffer_load_dwordx4 v15, s[28:31], s58 offen offset:3072 nt lds
    s_branch L_tail_end
L_tail13:
    s_waitcnt vmcnt(12)
    v_add_u32 v6, -3, v7
    ds_max_i32 v5, v6
    buffer_load_dwordx4 v12, s[28:31], s58 offen nt lds
    s_waitcnt vmcnt(12)
    buffer_load_dwordx4 v13, s[28:31], s58 offen offset:1024 nt lds
    s_waitcnt vmcnt(12)
    buffer_load_dwordx4 v14, s[28:31], s58 offen offset:2048 nt lds
    s_waitcnt vmcnt(12)
    buffer_load_dwordx4 v15, s[28:31], s58 offen offset:3072 nt lds
    s_branch L_tail_end
L_tail14:
    s_waitcnt vmcnt(13)
    buffer_load_dwordx4 v12, s[28:31], s58 offen nt lds
    s_waitcnt vmcnt(13)
    v_add_u32 v6, -3, v7
    ds_max_i32 v5, v6
    buffer_load_dwordx4 v13, s[28:31], s58 offen offset:1024 nt lds
    s_waitcnt vmcnt(13)
    buffer_load_dwordx4 v14, s[28:31], s58 offen offset:2048 nt lds
    s_waitcnt vmcnt(13)
    buffer_load_dwordx4 v15, s[28:31], s58 offen offset:3072 nt lds
    s_branch L_tail_end
L_tail15:
    s_waitcnt vmcnt(14)
    buffer_load_dwordx4 v12, s[28:31], s58 offen nt lds
    s_waitcnt vmcnt(14)
    buffer_load_dwordx4 v13, s[28:31], s58 offen offset:1024 nt lds
    s_waitcnt vmcnt(14)
    v_add_u32 v6, -3, v7
    ds_max_i32 v5, v6
    buffer_load_dwordx4 v14, s[28:31], s58 offen offset:2048 nt lds
    s_waitcnt vmcnt(14)
    buffer_load_dwordx4 v15, s[28:31], s58 offen offset:3072 nt lds
    s_branch L_tail_end
L_tail16:
    s_waitcnt vmcnt(15)
    buffer_load_dwordx4 v12, s[28:31], s58 offen nt lds
    s_waitcnt vmcnt(15)
    buffer_load_dwordx4 v13, s[28:31], s58 offen offset:1024 nt lds
    s_waitcnt vmcnt(15)
    buffer_load_dwordx4 v14, s[28:31], s58 offen offset:2048 nt lds
    s_waitcnt vmcnt(15)
    v_add_u32 v6, -3, v7
    ds_max_i32 v5, v6
    buffer_load_dwordx4 v15, s[28:31], s58 offen offset:3072 nt lds
    s_branch L_tail_end
L_tail17:
    s_waitcnt vmcnt(16)
    v_add_u32 v6, -4, v7
    ds_max_i32 v5, v6
    buffer_load_dwordx4 v12, s[28:31], s58 offen nt lds
    s_waitcnt vmcnt(16)
    buffer_load_dwordx4 v13, s[28:31], s58 offen offset:1024 nt lds
    s_waitcnt vmcnt(16)
    buffer_load_dwordx4 v14, s[28:31], s58 offen offset:2048 nt lds
    s_waitcnt vmcnt(16)
    buffer_load_dwordx4 v15, s[28:31], s58 offen offset:3072 nt lds
    s_branch L_tail_end
L_tail18:
    s_waitcnt vmcnt(17)
    buffer_load_dwordx4 v12, s[28:31], s58 offen nt lds
    s_waitcnt vmcnt(17)
    v_add_u32 v6, -4, v7
    ds_max_i32 v5, v6
    buffer_load_dwordx4 v13, s[28:31], s58 offen offset:1024 nt lds
    s_waitcnt vmcnt(17)
    buffer_load_dwordx4 v14, s[28:31], s58 offen offset:2048 nt lds
    s_waitcnt vmcnt(17)
    buffer_load_dwordx4 v15, s[28:31], s58 offen offset:3072 nt lds
    s_branch L_tail_end
L_tail19:
    s_waitcnt vmcnt(18)
    buffer_load_dwordx4 v12, s[28:31], s58 offen nt lds
    s_waitcnt vmcnt(18)
    buffer_load_dwordx4 v13, s[28:31], s58 offen offset:1024 nt lds
    s_waitcnt vmcnt(18)
    v_add_u32 v6, -4, v7
    ds_max_i32 v5, v6
    buffer_load_dwordx4 v14, s[28:31], s58 offen offset:2048 nt lds
    s_waitcnt vmcnt(18)
    buffer_load_dwordx4 v15, s[28:31], s58 offen offset:3072 nt lds
    s_branch L_tail_end
L_tail20:
    s_waitcnt vmcnt(19)
    buffer_load_dwordx4 v12, s[28:31], s58 offen nt lds
    s_waitcnt vmcnt(19)
    buffer_load_dwordx4 v13, s[28:31], s58 offen offset:1024 nt lds
    s_waitcnt vmcnt(19)
    buffer_load_dwordx4 v14, s[28:31], s58 offen offset:2048 nt lds
    s_waitcnt vmcnt(19)
    v_add_u32 v6, -4, v7
    ds_max_i32 v5, v6
    buffer_load_dwordx4 v15, s[28:31], s58 offen offset:3072 nt lds
    s_branch L_tail_end
L_tail21:
    s_waitcnt vmcnt(20)
    v_add_u32 v6, -5, v7
    ds_max_i32 v5, v6
    buffer_load_dwordx4 v12, s[28:31], s58 offen nt lds
    s_waitcnt vmcnt(20)
    buffer_load_dwordx4 v13, s[28:31], s58 offen offset:1024 nt lds
    s_waitcnt vmcnt(20)
    buffer_load_dwordx4 v14, s[28:31], s58 offen offset:2048 nt lds
    s_waitcnt vmcnt(20)
    buffer_load_dwordx4 v15, s[28:31], s58 offen offset:3072 nt lds
    s_branch L_tail_end
L_tail22:
    s_waitcnt vmcnt(21)
    buffer_load_dwordx4 v12, s[28:31], s58 offen nt lds
    s_waitcnt vmcnt(21)
    v_add_u32 v6, -5, v7
    ds_max_i32 v5, v6
    buffer_load_dwordx4 v13, s[28:31], s58 offen offset:1024 nt lds
    s_waitcnt vmcnt(21)
    buffer_load_dwordx4 v14, s[28:31], s58 offen offset:2048 nt lds
    s_waitcnt vmcnt(21)
    buffer_load_dwordx4 v15, s[28:31], s58 offen offset:3072 nt lds
    s_branch L_tail_end
L_tail23:
    s_waitcnt vmcnt(22)
    buffer_load_dwordx4 v12, s[28:31], s58 offen nt lds
    s_waitcnt vmcnt(22)
    buffer_load_dwordx4 v13, s[28:31], s58 offen offset:1024 nt lds
    s_waitcnt vmcnt(22)
    v_add_u32 v6, -5, v7
    ds_max_i32 v5, v6
    buffer_load_dwordx4 v14, s[28:31], s58 offen offset:2048 nt lds
    s_waitcnt vmcnt(22)
    buffer_load_dwordx4 v15, s[28:31], s58 offen offset:3072 nt lds
    s_branch L_tail_end
L_tail24:
    s_waitcnt vmcnt(23)
    buffer_load_dwordx4 v12, s[28:31], s58 offen nt lds
    s_waitcnt vmcnt(23)
    buffer_load_dwordx4 v13, s[28:31], s58 offen offset:1024 nt lds
    s_waitcnt vmcnt(23)
    buffer_load_dwordx4 v14, s[28:31], s58 offen offset:2048 nt lds
    s_waitcnt vmcnt(23)
    v_add_u32 v6, -5, v7
    ds_max_i32 v5, v6
    buffer_load_dwordx4 v15, s[28:31], s58 offen offset:3072 nt lds
    s_branch L_tail_end
L_tail25:
    s_waitcnt vmcnt(24)
    v_add_u32 v6, -6, v7
    ds_max_i32 v5, v6
    buffer_load_dwordx4 v12, s[28:31], s58 offen nt lds
    s_waitcnt vmcnt(24)
    buffer_load_dwordx4 v13, s[28:31], s58 offen offset:1024 nt lds
    s_waitcnt vmcnt(24)
    buffer_load_dwordx4 v14, s[28:31], s58 offen offset:2048 nt lds
    s_waitcnt vmcnt(24)
    buffer_load_dwordx4 v15, s[28:31], s58 offen offset:3072 nt lds
    s_branch L_tail_end
L_tail26:
    s_waitcnt vmcnt(25)
    buffer_load_dwordx4 v12, s[28:31], s58 offen nt lds
    s_waitcnt vmcnt(25)
    v_add_u32 v6, -6, v7
    ds_max_i32 v5, v6
    buffer_load_dwordx4 v13, s[28:31], s58 offen offset:1024 nt lds
    s_waitcnt vmcnt(25)
    buffer_load_dwordx4 v14, s[28:31], s58 offen offset:2048 nt lds
    s_waitcnt vmcnt(25)
    buffer_load_dwordx4 v15, s[28:31], s58 offen offset:3072 nt lds
    s_branch L_tail_end
L_tail27:
    s_waitcnt vmcnt(26)
    buffer_load_dwordx4 v12, s[28:31], s58 offen nt lds
    s_waitcnt vmcnt(26)
    buffer_load_dwordx4 v13, s[28:31], s58 offen offset:1024 nt lds
    s_waitcnt vmcnt(26)
    v_add_u32 v6, -6, v7
    ds_max_i32 v5, v6
    buffer_load_dwordx4 v14, s[28:31], s58 offen offset:2048 nt lds
    s_waitcnt vmcnt(26)
    buffer_load_dwordx4 v15, s[28:31], s58 offen offset:3072 nt lds
    s_branch L_tail_end
L_tail28:
    s_waitcnt vmcnt(27)
    buffer_load_dwordx4 v12, s[28:31], s58 offen nt lds
    s_waitcnt vmcnt(27)
    buffer_load_dwordx4 v13, s[28:31], s58 offen offset:1024 nt lds
    s_waitcnt vmcnt(27)
    buffer_load_dwordx4 v14, s[28:31], s58 offen offset:2048 nt lds
    s_waitcnt vmcnt(27)
    v_add_u32 v6, -6, v7
    ds_max_i32 v5, v6
    buffer_load_dwordx4 v15, s[28:31], s58 offen offset:3072 nt lds
    s_branch L_tail_end
L_tail29:
    s_waitcnt vmcnt(28)
    v_add_u32 v6, -7, v7
    ds_max_i32 v5, v6
    buffer_load_dwordx4 v12, s[28:31], s58 offen nt lds
    s_waitcnt vmcnt(28)
    buffer_load_dwordx4 v13, s[28:31], s58 offen offset:1024 nt lds
    s_waitcnt vmcnt(28)
    buffer_load_dwordx4 v14, s[28:31], s58 offen offset:2048 nt lds
    s_waitcnt vmcnt(28)
    buffer_load_dwordx4 v15, s[28:31], s58 offen offset:3072 nt lds
    s_branch L_tail_end
L_tail30:
    s_waitcnt vmcnt(29)
    buffer_load_dwordx4 v12, s[28:31], s58 offen nt lds
    s_waitcnt vmcnt(29)
    v_add_u32 v6, -7, v7
    ds_max_i32 v5, v6
    buffer_load_dwordx4 v13, s[28:31], s58 offen offset:1024 nt lds
    s_waitcnt vmcnt(29)
    buffer_load_dwordx4 v14, s[28:31], s58 offen offset:2048 nt lds
    s_waitcnt vmcnt(29)
    buffer_load_dwordx4 v15, s[28:31], s58 offen offset:3072 nt lds
    s_branch L_tail_end
L_tail_end:
    v_add_u32 v7, 1, v7
    s_cmp_lt_u32 s53, s22
    s_cbranch_scc1 L_tail_next
    s_waitcnt vmcnt(28)
    v_add_u32 v6, -7, v20
    ds_max_i32 v5, v6
    s_waitcnt vmcnt(24)
    v_add_u32 v6, -6, v20
    ds_max_i32 v5, v6
    s_waitcnt vmcnt(20)
    v_add_u32 v6, -5, v20
    ds_max_i32 v5, v6
    s_waitcnt vmcnt(16)
    v_add_u32 v6, -4, v20
    ds_max_i32 v5, v6
    s_waitcnt vmcnt(12)
    v_add_u32 v6, -3, v20
    ds_max_i32 v5, v6
    s_barrier
    s_waitcnt vmcnt(8)
    v_add_u32 v6, -2, v20
    ds_max_i32 v5, v6
    s_waitcnt vmcnt(4)
    v_add_u32 v6, -1, v20
    ds_max_i32 v5, v6
    s_waitcnt vmcnt(0)
    v_add_u32 v6, 0, v20
    ds_max_i32 v5, v6
    ds_read_b32 v6, v32
    s_barrier
    s_cmp_eq_u32 s15, 0
    s_cbranch_scc1 L_end
    s_waitcnt lgkmcnt(0)
    v_readlane_b32 s57, v6, 2
    v_readlane_b32 s60, v6, 9
    s_add_u32 s57, s57, s14
    s_cmp_eq_u32 s57, 0x103
    s_cbranch_scc1 L_lown
    s_cmp_lg_u32 s57, 0x101
    s_cbranch_scc1 L_end
    s_cmp_lg_u32 s60, 2
    s_cbranch_scc1 L_end
    v_readlane_b32 s20, v6, 3
    v_readlane_b32 s56, v6, 4
    s_mov_b32 s14, 1
    s_branch L_lrestart
L_lown:
    s_lshl_b32 s20, s17, 9
    s_mov_b32 s56, s12
    s_mov_b32 s40, s13
    s_mov_b32 s14, 2
L_lrestart:
    v_mov_b32 v19, 0
    ds_write_b32 v5, v19
    s_barrier
    s_branch L_ljob
L_notloader:
    s_cmp_lt_u32 s16, 5
    s_cbranch_scc1 L_consumer
    v_and_b32 v23, 0x7c, v4
    v_and_b32 v32, 0x3c, v4
    v_add_u32 v32, 132864, v32
    v_mov_b32 v6, 0
    ds_write_b32 v32, v6
    s_movk_i32 s38, 0x80
    s_mov_b32 s39, 0x20000
    s_movk_i32 s30, 0x100
    s_mov_b32 s31, 0x20000
    s_waitcnt lgkmcnt(0)
    s_mov_b32 s36, s72
    s_mov_b32 s37, s73
    buffer_load_dword v17, v23, s[36:39], 0 offen
    s_mov_b32 s28, s76
    s_mov_b32 s29, s77
    s_lshr_b32 s3, s6, 8
    s_add_u32 s3, s3, s18
    s_and_b32 s3, s3, 3
    s_cmp_eq_u32 s3, 1
    s_cselect_b32 s15, 1, 0
    s_barrier
    s_cmp_eq_u32 s15, 0
    s_cbranch_scc1 L_end
    s_waitcnt vmcnt(0)
    v_add_u32 v16, -1, v17
    v_min_u32 v16, 0x7ff, v16
    v_lshrrev_b32 v18, 4, v16
    v_lshrrev_b32 v19, 2, v23
    v_mov_b32 v27, v18
    v_lshl_add_u32 v19, v18, 5, v19
    v_mov_b32 v20, 0
    v_mov_b32 v21, 0
    v_readlane_b32 s40, v19, 0
    v_readlane_b32 s41, v19, 1
    v_readlane_b32 s42, v19, 2
    v_readlane_b32 s43, v19, 3
    v_cmp_lt_u32 s[44:45], s40, v19
    v_cmp_lt_u32 s[46:47], s41, v19
    v_cmp_lt_u32 s[48:49], s42, v19
    v_cmp_lt_u32 s[50:51], s43, v19
    v_addc_co_u32 v20, vcc, v20, v21, s[44:45]
    v_addc_co_u32 v20, vcc, v20, v21, s[46:47]
    v_addc_co_u32 v20, vcc, v20, v21, s[48:49]
    v_addc_co_u32 v20, vcc, v20, v21, s[50:51]
    v_readlane_b32 s40, v19, 4
    v_readlane_b32 s41, v19, 5
    v_readlane_b32 s42, v19, 6
    v_readlane_b32 s43, v19, 7
    v_cmp_lt_u32 s[44:45], s40, v19
    v_cmp_lt_u32 s[46:47], s41, v19
    v_cmp_lt_u32 s[48:49], s42, v19
    v_cmp_lt_u32 s[50:51], s43, v19
    v_addc_co_u32 v20, vcc, v20, v21, s[44:45]
    v_addc_co_u32 v20, vcc, v20, v21, s[46:47]
    v_addc_co_u32 v20, vcc, v20, v21, s[48:49]
    v_addc_co_u32 v20, vcc, v20, v21, s[50:51]
    v_readlane_b32 s40, v19, 8
    v_readlane_b32 s41, v19, 9
    v_readlane_b32 s42, v19, 10
    v_readlane_b32 s43, v19, 11
    v_cmp_lt_u32 s[44:45], s40, v19
    v_cmp_lt_u32 s[46:47], s41, v19
    v_cmp_lt_u32 s[48:49], s42, v19
    v_cmp_lt_u32 s[50:51], s43, v19
    v_addc_co_u32 v20, vcc, v20, v21, s[44:45]
    v_addc_co_u32 v20, vcc, v20, v21, s[46:47]
    v_addc_co_u32 v20, vcc, v20, v21, s[48:49]
    v_addc_co_u32 v20, vcc, v20, v21, s[50:51]
    v_readlane_b32 s40, v19, 12
    v_readlane_b32 s41, v19, 13
    v_readlane_b32 s42, v19, 14
    v_readlane_b32 s43, v19, 15
    v_cmp_lt_u32 s[44:45], s40, v19
    v_cmp_lt_u32 s[46:47], s41, v19
    v_cmp_lt_u32 s[48:49], s42, v19
    v_cmp_lt_u32 s[50:51], s43, v19
    v_addc_co_u32 v20, vcc, v20, v21, s[44:45]
    v_addc_co_u32 v20, vcc, v20, v21, s[46:47]
    v_addc_co_u32 v20, vcc, v20, v21, s[48:49]
    v_addc_co_u32 v20, vcc, v20, v21, s[50:51]
    v_readlane_b32 s40, v19, 16
    v_readlane_b32 s41, v19, 17
    v_readlane_b32 s42, v19, 18
    v_readlane_b32 s43, v19, 19
    v_cmp_lt_u32 s[44:45], s40, v19
    v_cmp_lt_u32 s[46:47], s41, v19
    v_cmp_lt_u32 s[48:49], s42, v19
    v_cmp_lt_u32 s[50:51], s43, v19
    v_addc_co_u32 v20, vcc, v20, v21, s[44:45]
    v_addc_co_u32 v20, vcc, v20, v21, s[46:47]
    v_addc_co_u32 v20, vcc, v20, v21, s[48:49]
    v_addc_co_u32 v20, vcc, v20, v21, s[50:51]
    v_readlane_b32 s40, v19, 20
    v_readlane_b32 s41, v19, 21
    v_readlane_b32 s42, v19, 22
    v_readlane_b32 s43, v19, 23
    v_cmp_lt_u32 s[44:45], s40, v19
    v_cmp_lt_u32 s[46:47], s41, v19
    v_cmp_lt_u32 s[48:49], s42, v19
    v_cmp_lt_u32 s[50:51], s43, v19
    v_addc_co_u32 v20, vcc, v20, v21, s[44:45]
    v_addc_co_u32 v20, vcc, v20, v21, s[46:47]
    v_addc_co_u32 v20, vcc, v20, v21, s[48:49]
    v_addc_co_u32 v20, vcc, v20, v21, s[50:51]
    v_readlane_b32 s40, v19, 24
    v_readlane_b32 s41, v19, 25
    v_readlane_b32 s42, v19, 26
    v_readlane_b32 s43, v19, 27
    v_cmp_lt_u32 s[44:45], s40, v19
    v_cmp_lt_u32 s[46:47], s41, v19
    v_cmp_lt_u32 s[48:49], s42, v19
    v_cmp_lt_u32 s[50:51], s43, v19
    v_addc_co_u32 v20, vcc, v20, v21, s[44:45]
    v_addc_co_u32 v20, vcc, v20, v21, s[46:47]
    v_addc_co_u32 v20, vcc, v20, v21, s[48:49]
    v_addc_co_u32 v20, vcc, v20, v21, s[50:51]
    v_readlane_b32 s40, v19, 28
    v_readlane_b32 s41, v19, 29
    v_readlane_b32 s42, v19, 30
    v_readlane_b32 s43, v19, 31
    v_cmp_lt_u32 s[44:45], s40, v19
    v_cmp_lt_u32 s[46:47], s41, v19
    v_cmp_lt_u32 s[48:49], s42, v19
    v_cmp_lt_u32 s[50:51], s43, v19
    v_addc_co_u32 v20, vcc, v20, v21, s[44:45]
    v_addc_co_u32 v20, vcc, v20, v21, s[46:47]
    v_addc_co_u32 v20, vcc, v20, v21, s[48:49]
    v_addc_co_u32 v20, vcc, v20, v21, s[50:51]
    v_add_u32_dpp v27, v27, v27 row_shr:1 row_mask:0xf bank_mask:0xf bound_ctrl:0
    s_nop 1
    v_add_u32_dpp v27, v27, v27 row_shr:2 row_mask:0xf bank_mask:0xf bound_ctrl:0
    s_nop 1
    v_add_u32_dpp v27, v27, v27 row_shr:4 row_mask:0xf bank_mask:0xf bound_ctrl:0
    s_nop 1
    v_add_u32_dpp v27, v27, v27 row_shr:8 row_mask:0xf bank_mask:0xf bound_ctrl:0
    s_nop 1
    v_readlane_b32 s50, v27, 15
    v_readlane_b32 s51, v27, 31
    v_readlane_b32 s40, v20, s17
    v_readlane_b32 s41, v16, s17
    s_sub_u32 s42, 31, s40
    v_cmp_eq_u32 vcc, s42, v20
    s_add_u32 s50, s50, s51
    s_add_u32 s50, s50, 32
    s_ff1_i32_b32 s42, vcc_lo
    s_and_b32 s42, s42, 31
    s_cmp_ge_u32 s40, 16
    s_cselect_b32 s43, s17, s42
    s_cselect_b32 s44, s42, s17
    s_cselect_b32 s45, 1, 2
    v_readlane_b32 s46, v16, s43
    v_readlane_b32 s47, v18, s44
    v_readlane_b32 s48, v17, s43
    s_mul_i32 s49, s50, 2341
    s_lshr_b32 s49, s49, 16
    s_max_u32 s49, s49, 24
    s_lshr_b32 s52, s46, 4
    s_add_u32 s52, s52, 1
    s_sub_u32 s52, s52, s49
    v_cvt_f32_u32 v8, s50
    v_cvt_f32_i32 v9, s52
    s_add_u32 s53, s47, 1
    v_cvt_f32_u32 v10, s53
    v_mul_f32 v8, 0x3d000000, v8
    v_fmac_f32 v8, 0xbf4ccccd, v9
    v_add_f32 v8, 0xc1500000, v8
    v_max_f32 v8, 1.0, v8
    v_rcp_f32 v8, v8
    s_lshl_b32 s57, s43, 9
    s_lshl_b32 s58, s49, 2
    s_add_u32 s57, s57, s58
    v_mul_f32 v8, v8, v10
    v_mul_f32 v8, 0x42a80000, v8
    v_cvt_u32_f32 v8, v8
    s_lshl_b32 s55, s49, 4
    s_sub_u32 s58, s46, s55
    v_readfirstlane_b32 s60, v8
    s_cmp_ge_i32 s52, 5
    s_cselect_b32 s45, s45, 0
    s_cmp_le_u32 s60, 96
    s_cselect_b32 s45, s45, 0
    s_cmp_ge_u32 s47, 7
    s_cselect_b32 s45, s45, 0
    s_sub_u32 s56, s55, 1
    s_cmp_eq_u32 s45, 1
    s_cselect_b32 s56, s56, s41
    s_lshl_b32 s59, s43, 3
    s_add_u32 s59, s59, s18
    s_lshl_b32 s61, s59, 12
    s_cmp_lt_i32 s48, 1
    s_cselect_b32 s62, 0, 0x3e0293ee
    s_or_b32 s63, s45, 0x100
    s_mov_b64 exec, 1
    v_mov_b32 v6, 132864
    v_mov_b32 v7, s56
    ds_write_b32 v6, v7 offset:0
    v_mov_b32 v7, s60
    ds_write_b32 v6, v7 offset:4
    v_mov_b32 v7, s57
    ds_write_b32 v6, v7 offset:12
    v_mov_b32 v7, s58
    ds_write_b32 v6, v7 offset:16
    v_mov_b32 v7, s61
    ds_write_b32 v6, v7 offset:20
    v_mov_b32 v7, s62
    ds_write_b32 v6, v7 offset:24
    v_mov_b32 v7, s59
    ds_write_b32 v6, v7 offset:28
    v_mov_b32 v7, s63
    ds_write_b32 v6, v7 offset:8
    s_cmp_lg_u32 s45, 1
    s_cbranch_scc1 L_end
    s_mul_i32 s36, s49, 205
    s_lshr_b32 s36, s36, 8
    v_mov_b32 v10, s59
L_pl_wait:
    ds_read_b32 v8, v5
    s_waitcnt lgkmcnt(0)
    v_readfirstlane_b32 s38, v8
    s_cmp_lt_i32 s38, s36
    s_cbranch_scc1 L_pl_wait
L_pl_poll:
    buffer_load_ubyte v8, v10, s[28:31], 0 offen sc1
    ds_read_b32 v9, v6 offset:36
    s_waitcnt vmcnt(0) lgkmcnt(0)
    v_readfirstlane_b32 s38, v8
    v_readfirstlane_b32 s39, v9
    s_cmp_lg_u32 s39, 0
    s_cbranch_scc1 L_end
    s_cmp_eq_u32 s38, 0
    s_cbranch_scc1 L_pl_poll
    ds_write_b32 v6, v8 offset:32
    s_waitcnt lgkmcnt(0)
    s_endpgm
L_consumer:
    s_sub_u32 s16, s16, 1
    s_lshl_b32 s19, s16, 8
    s_add_u32 s19, s19, 131328
    v_add_u32 v6, s19, v4
    v_mov_b32 v9, 0
    ds_write_b32 v6, v9
    v_lshlrev_b32 v10, 8, v3
    v_lshl_add_u32 v15, v2, 4, v10
    s_lshl_b32 s22, s17, 2
    s_lshl_b32 s23, s2, 12
    s_mov_b32 s30, 0x100000
    s_mov_b32 s31, 0x20000
    s_mov_b32 s14, 0
    s_mov_b32 s70, 0
    s_lshl_b32 s41, s16, 6
    s_add_u32 s69, s23, s41
    s_waitcnt lgkmcnt(0)
    s_load_dword s24, s[72:73], s22
    s_mov_b32 s28, s4
    s_mov_b32 s29, s5
    s_mov_b32 s32, s74
    s_mov_b32 s33, s75
    s_mov_b32 s34, 0x100000
    s_mov_b32 s35, 0x20000
    s_mov_b32 s64, s78
    s_mov_b32 s65, s79
    s_mov_b32 s66, 0x400000
    s_mov_b32 s67, 0x20000
    s_lshr_b32 s3, s6, 8
    s_add_u32 s3, s3, s18
    s_and_b32 s3, s3, 3
    s_cmp_eq_u32 s3, 1
    s_cselect_b32 s15, 1, 0
L_cjob:
    buffer_load_dwordx4 v[16:19], v15, s[28:31], s23 offen offset:0
    buffer_load_dwordx4 v[20:23], v15, s[28:31], s23 offen offset:64
    buffer_load_dwordx4 v[24:27], v15, s[28:31], s23 offen offset:128
    buffer_load_dwordx4 v[28:31], v15, s[28:31], s23 offen offset:192
    s_barrier
    s_lshl_b32 s20, s16, 13
    v_xor_b32 v10, v2, v3
    v_lshlrev_b32 v10, 4, v10
    v_lshl_add_u32 v10, v3, 8, v10
    v_add_u32 v104, s20, v10
    v_xor_b32 v105, 64, v104
    v_xor_b32 v106, 128, v104
    v_xor_b32 v107, 192, v104
    v_lshrrev_b32 v10, 2, v0
    v_and_b32 v11, 7, v10
    v_lshlrev_b32 v11, 5, v11
    v_lshl_add_u32 v11, v10, 8, v11
    v_and_b32 v12, 3, v0
    v_lshl_add_u32 v11, v12, 3, v11
    s_add_u32 s21, s20, 4096
    v_add_u32 v108, s21, v11
    v_xor_b32 v109, 32, v108
    v_xor_b32 v110, 64, v108
    v_xor_b32 v111, 96, v108
    v_xor_b32 v112, 128, v108
    v_xor_b32 v113, 160, v108
    v_xor_b32 v114, 192, v108
    v_xor_b32 v115, 224, v108
    v_add_u32 v128, 0x10000, v104
    v_add_u32 v129, 0x10000, v105
    v_add_u32 v130, 0x10000, v106
    v_add_u32 v131, 0x10000, v107
    v_add_u32 v132, 0x10000, v108
    v_add_u32 v133, 0x10000, v109
    v_add_u32 v134, 0x10000, v110
    v_add_u32 v135, 0x10000, v111
    v_add_u32 v136, 0x10000, v112
    v_add_u32 v137, 0x10000, v113
    v_add_u32 v138, 0x10000, v114
    v_add_u32 v139, 0x10000, v115
    v_lshlrev_b32 v8, 2, v2
    v_mov_b32 v72, 0
    v_mov_b32 v73, 0
    v_mov_b32 v74, 0
    v_mov_b32 v75, 0
    v_mov_b32 v76, 0
    v_mov_b32 v77, 0
    v_mov_b32 v78, 0
    v_mov_b32 v79, 0
    v_mov_b32 v80, 0
    v_mov_b32 v81, 0
    v_mov_b32 v82, 0
    v_mov_b32 v83, 0
    v_mov_b32 v84, 0
    v_mov_b32 v85, 0
    v_mov_b32 v86, 0
    v_mov_b32 v87, 0
    v_mov_b32 v88, 0
    v_mov_b32 v89, 0
    v_mov_b32 v90, 0
    v_mov_b32 v91, 0
    v_mov_b32 v92, 0
    v_mov_b32 v93, 0
    v_mov_b32 v94, 0
    v_mov_b32 v95, 0
    v_mov_b32 v96, 0
    v_mov_b32 v97, 0
    v_mov_b32 v98, 0
    v_mov_b32 v99, 0
    v_mov_b32 v100, 0
    v_mov_b32 v101, 0
    v_mov_b32 v102, 0
    v_mov_b32 v103, 0
    v_mov_b32 v116, 0xf149f2ca
    v_mov_b32 v117, 0
    s_cmp_lg_u32 s14, 0
    s_cbranch_scc1 L_cj2
    s_waitcnt lgkmcnt(0)
    s_mov_b32 s26, 0x3e0293ee
    s_cmp_lt_i32 s24, 1
    s_cselect_b32 s26, 0, s26
    s_sub_u32 s24, s24, 1
    s_min_u32 s24, s24, 0x7ff
    s_cmp_eq_u32 s15, 0
    s_cbranch_scc1 L_cj2
    v_and_b32 v10, 0x3c, v4
    v_add_u32 v10, 132864, v10
L_cplan:
    ds_read_b32 v11, v10
    s_waitcnt lgkmcnt(0)
    v_readlane_b32 s40, v11, 2
    s_cmp_eq_u32 s40, 0
    s_cbranch_scc1 L_cplan
    v_readlane_b32 s24, v11, 0
    v_readlane_b32 s56, v11, 4
    v_readlane_b32 s57, v11, 5
    v_readlane_b32 s58, v11, 6
    v_readlane_b32 s59, v11, 7
    s_and_b32 s70, s40, 1
    s_lshl_b32 s68, s59, 14
    s_cmp_lg_u32 s40, 0x102
    s_cbranch_scc1 L_cj2
    s_mov_b32 s12, s24
    s_mov_b32 s13, s26
    s_mov_b32 s70, 2
    s_branch L_job2
L_cj2:
    s_lshr_b32 s50, s24, 4
    s_add_u32 s25, s50, 1
    s_add_u32 s24, s24, 1
    s_mov_b32 s27, s16
    s_max_u32 s53, s25, 3
    s_add_u32 s53, s53, 1
    s_lshl_b32 s37, s16, 4
    s_sub_u32 s37, s24, s37
    s_mov_b32 s38, 0
    s_mov_b32 s39, 0xf149f2ca
    s_lshr_b32 s51, s50, 2
    s_add_u32 s51, s51, 1
    s_and_b32 s51, s51, 3
    s_lshl_b32 s51, s51, 15
    v_lshlrev_b32 v10, 4, v3
    v_add_u32 v11, 132352, v10
    s_lshl_b32 s40, s16, 2
    v_lshl_add_u32 v13, v2, 9, v10
    v_add_u32 v10, s40, v11
    s_lshl_b32 s41, s16, 11
    s_add_u32 s41, s41, s51
    v_add_u32 v13, s41, v13
    s_add_u32 s41, s20, s51
    v_lshlrev_b32 v12, 4, v0
    s_lshl_b32 s40, s16, 10
    v_add_u32 v14, s40, v12
    v_add_u32 v12, s41, v12
    s_sub_u32 s52, s25, 4
    s_waitcnt vmcnt(0)
    s_cmp_ge_u32 s27, s25
    s_cbranch_scc1 L_noblock
L_cloop:
    s_cmp_ge_i32 s27, s52
    s_cbranch_scc1 L_final
    s_lshl_b32 s54, s27, 1
    s_sub_u32 s36, s54, 3
    s_max_i32 s36, s36, s27
    s_add_u32 s36, s36, 1
    s_cmp_ge_i32 s38, s36
    s_cbranch_scc1 L_okk0
L_pollk0:
    ds_read_b32 v7, v5
    s_waitcnt lgkmcnt(0)
    v_readfirstlane_b32 s38, v7
    s_cmp_lt_i32 s38, s36
    s_cbranch_scc1 L_pollk0
L_okk0:
    ds_read_b128 v[32:35], v104 offset:0
    ds_read_b128 v[36:39], v105 offset:0
    ds_read_b128 v[40:43], v106 offset:0
    ds_read_b128 v[44:47], v107 offset:0
    s_waitcnt lgkmcnt(3)
    v_mfma_f32_16x16x32_bf16 v[64:67], v[32:35], v[16:19], 0
    s_waitcnt lgkmcnt(2)
    v_mfma_f32_16x16x32_bf16 v[64:67], v[36:39], v[20:23], v[64:67]
    s_waitcnt lgkmcnt(1)
    v_mfma_f32_16x16x32_bf16 v[64:67], v[40:43], v[24:27], v[64:67]
    s_waitcnt lgkmcnt(0)
    v_mfma_f32_16x16x32_bf16 v[64:67], v[44:47], v[28:31], v[64:67]
    s_add_u32 s36, s54, 5
    s_add_u32 s54, s53, s27
    s_min_i32 s36, s36, s54
    s_nop 4
    v_max_f32 v121, v64, v65
    v_max3_f32 v121, v66, v67, v121
    v_mov_b32 v122, v121
    s_nop 1
    v_permlane16_swap_b32 v121, v122
    v_max_f32 v121, v121, v122
    v_mov_b32 v122, v121
    s_nop 1
    v_permlane32_swap_b32 v121, v122
    v_max3_f32 v118, v121, v122, v116
    v_sub_f32 v123, v116, v118
    v_mul_f32 v119, s26, v118
    v_mul_f32 v123, s26, v123
    v_fma_f32 v124, v64, s26, -v119
    v_fma_f32 v125, v65, s26, -v119
    v_fma_f32 v126, v66, s26, -v119
    v_fma_f32 v127, v67, s26, -v119
    v_exp_f32 v120, v123
    v_exp_f32 v124, v124
    v_exp_f32 v125, v125
    v_exp_f32 v126, v126
    v_exp_f32 v127, v127
    v_mov_b32 v116, v118
    v_mul_f32 v72, v120, v72
    v_mul_f32 v73, v120, v73
    v_mul_f32 v74, v120, v74
    v_mul_f32 v75, v120, v75
    v_mul_f32 v76, v120, v76
    v_mul_f32 v77, v120, v77
    v_mul_f32 v78, v120, v78
    v_mul_f32 v79, v120, v79
    v_mul_f32 v80, v120, v80
    v_mul_f32 v81, v120, v81
    v_mul_f32 v82, v120, v82
    v_mul_f32 v83, v120, v83
    v_mul_f32 v84, v120, v84
    v_mul_f32 v85, v120, v85
    v_mul_f32 v86, v120, v86
    v_mul_f32 v87, v120, v87
    v_mul_f32 v88, v120, v88
    v_mul_f32 v89, v120, v89
    v_mul_f32 v90, v120, v90
    v_mul_f32 v91, v120, v91
    v_mul_f32 v92, v120, v92
    v_mul_f32 v93, v120, v93
    v_mul_f32 v94, v120, v94
    v_mul_f32 v95, v120, v95
    v_mul_f32 v96, v120, v96
    v_mul_f32 v97, v120, v97
    v_mul_f32 v98, v120, v98
    v_mul_f32 v99, v120, v99
    v_mul_f32 v100, v120, v100
    v_mul_f32 v101, v120, v101
    v_mul_f32 v102, v120, v102
    v_mul_f32 v103, v120, v103
    v_add_f32 v121, v124, v125
    v_add_f32 v122, v126, v127
    v_cvt_pk_bf16_f32 v68, v124, v125
    v_cvt_pk_bf16_f32 v69, v126, v127
    v_add_f32 v121, v121, v122
    v_fma_f32 v117, v117, v120, v121
    s_cmp_ge_i32 s38, s36
    s_cbranch_scc1 L_okv0
L_pollv0:
    ds_read_b32 v7, v5
    s_waitcnt lgkmcnt(0)
    v_readfirstlane_b32 s38, v7
    s_cmp_lt_i32 s38, s36
    s_cbranch_scc1 L_pollv0
L_okv0:
    ds_read_b64_tr_b16 v[48:49], v108 offset:0
    ds_read_b64_tr_b16 v[50:51], v109 offset:0
    ds_read_b64_tr_b16 v[52:53], v110 offset:0
    ds_read_b64_tr_b16 v[54:55], v111 offset:0
    ds_read_b64_tr_b16 v[56:57], v112 offset:0
    ds_read_b64_tr_b16 v[58:59], v113 offset:0
    ds_read_b64_tr_b16 v[60:61], v114 offset:0
    ds_read_b64_tr_b16 v[62:63], v115 offset:0
    s_add_u32 s27, s27, 1
    v_mov_b32 v9, s27
    s_waitcnt lgkmcnt(7)
    v_mfma_f32_16x16x16_bf16 v[72:75], v[48:49], v[68:69], v[72:75]
    s_waitcnt lgkmcnt(6)
    v_mfma_f32_16x16x16_bf16 v[76:79], v[50:51], v[68:69], v[76:79]
    s_waitcnt lgkmcnt(5)
    v_mfma_f32_16x16x16_bf16 v[80:83], v[52:53], v[68:69], v[80:83]
    s_waitcnt lgkmcnt(4)
    v_mfma_f32_16x16x16_bf16 v[84:87], v[54:55], v[68:69], v[84:87]
    s_waitcnt lgkmcnt(3)
    v_mfma_f32_16x16x16_bf16 v[88:91], v[56:57], v[68:69], v[88:91]
    s_waitcnt lgkmcnt(2)
    v_mfma_f32_16x16x16_bf16 v[92:95], v[58:59], v[68:69], v[92:95]
    s_waitcnt lgkmcnt(1)
    v_mfma_f32_16x16x16_bf16 v[96:99], v[60:61], v[68:69], v[96:99]
    s_waitcnt lgkmcnt(0)
    ds_write_b32 v6, v9
    v_mfma_f32_16x16x16_bf16 v[100:103], v[62:63], v[68:69], v[100:103]
    s_add_u32 s27, s27, 3
    s_sub_u32 s37, s37, 64
    s_cmp_ge_i32 s27, s52
    s_cbranch_scc1 L_final
    s_lshl_b32 s54, s27, 1
    s_sub_u32 s36, s54, 3
    s_max_i32 s36, s36, s27
    s_add_u32 s36, s36, 1
    s_cmp_ge_i32 s38, s36
    s_cbranch_scc1 L_okk1
L_pollk1:
    ds_read_b32 v7, v5
    s_waitcnt lgkmcnt(0)
    v_readfirstlane_b32 s38, v7
    s_cmp_lt_i32 s38, s36
    s_cbranch_scc1 L_pollk1
L_okk1:
    ds_read_b128 v[32:35], v104 offset:32768
    ds_read_b128 v[36:39], v105 offset:32768
    ds_read_b128 v[40:43], v106 offset:32768
    ds_read_b128 v[44:47], v107 offset:32768
    s_waitcnt lgkmcnt(3)
    v_mfma_f32_16x16x32_bf16 v[64:67], v[32:35], v[16:19], 0
    s_waitcnt lgkmcnt(2)
    v_mfma_f32_16x16x32_bf16 v[64:67], v[36:39], v[20:23], v[64:67]
    s_waitcnt lgkmcnt(1)
    v_mfma_f32_16x16x32_bf16 v[64:67], v[40:43], v[24:27], v[64:67]
    s_waitcnt lgkmcnt(0)
    v_mfma_f32_16x16x32_bf16 v[64:67], v[44:47], v[28:31], v[64:67]
    s_add_u32 s36, s54, 5
    s_add_u32 s54, s53, s27
    s_min_i32 s36, s36, s54
    s_nop 4
    v_max_f32 v121, v64, v65
    v_max3_f32 v121, v66, v67, v121
    v_mov_b32 v122, v121
    s_nop 1
    v_permlane16_swap_b32 v121, v122
    v_max_f32 v121, v121, v122
    v_mov_b32 v122, v121
    s_nop 1
    v_permlane32_swap_b32 v121, v122
    v_max3_f32 v118, v121, v122, v116
    v_sub_f32 v123, v116, v118
    v_mul_f32 v119, s26, v118
    v_mul_f32 v123, s26, v123
    v_fma_f32 v124, v64, s26, -v119
    v_fma_f32 v125, v65, s26, -v119
    v_fma_f32 v126, v66, s26, -v119
    v_fma_f32 v127, v67, s26, -v119
    v_exp_f32 v120, v123
    v_exp_f32 v124, v124
    v_exp_f32 v125, v125
    v_exp_f32 v126, v126
    v_exp_f32 v127, v127
    v_mov_b32 v116, v118
    v_mul_f32 v72, v120, v72
    v_mul_f32 v73, v120, v73
    v_mul_f32 v74, v120, v74
    v_mul_f32 v75, v120, v75
    v_mul_f32 v76, v120, v76
    v_mul_f32 v77, v120, v77
    v_mul_f32 v78, v120, v78
    v_mul_f32 v79, v120, v79
    v_mul_f32 v80, v120, v80
    v_mul_f32 v81, v120, v81
    v_mul_f32 v82, v120, v82
    v_mul_f32 v83, v120, v83
    v_mul_f32 v84, v120, v84
    v_mul_f32 v85, v120, v85
    v_mul_f32 v86, v120, v86
    v_mul_f32 v87, v120, v87
    v_mul_f32 v88, v120, v88
    v_mul_f32 v89, v120, v89
    v_mul_f32 v90, v120, v90
    v_mul_f32 v91, v120, v91
    v_mul_f32 v92, v120, v92
    v_mul_f32 v93, v120, v93
    v_mul_f32 v94, v120, v94
    v_mul_f32 v95, v120, v95
    v_mul_f32 v96, v120, v96
    v_mul_f32 v97, v120, v97
    v_mul_f32 v98, v120, v98
    v_mul_f32 v99, v120, v99
    v_mul_f32 v100, v120, v100
    v_mul_f32 v101, v120, v101
    v_mul_f32 v102, v120, v102
    v_mul_f32 v103, v120, v103
    v_add_f32 v121, v124, v125
    v_add_f32 v122, v126, v127
    v_cvt_pk_bf16_f32 v68, v124, v125
    v_cvt_pk_bf16_f32 v69, v126, v127
    v_add_f32 v121, v121, v122
    v_fma_f32 v117, v117, v120, v121
    s_cmp_ge_i32 s38, s36
    s_cbranch_scc1 L_okv1
L_pollv1:
    ds_read_b32 v7, v5
    s_waitcnt lgkmcnt(0)
    v_readfirstlane_b32 s38, v7
    s_cmp_lt_i32 s38, s36
    s_cbranch_scc1 L_pollv1
L_okv1:
    ds_read_b64_tr_b16 v[48:49], v108 offset:32768
    ds_read_b64_tr_b16 v[50:51], v109 offset:32768
    ds_read_b64_tr_b16 v[52:53], v110 offset:32768
    ds_read_b64_tr_b16 v[54:55], v111 offset:32768
    ds_read_b64_tr_b16 v[56:57], v112 offset:32768
    ds_read_b64_tr_b16 v[58:59], v113 offset:32768
    ds_read_b64_tr_b16 v[60:61], v114 offset:32768
    ds_read_b64_tr_b16 v[62:63], v115 offset:32768
    s_add_u32 s27, s27, 1
    v_mov_b32 v9, s27
    s_waitcnt lgkmcnt(7)
    v_mfma_f32_16x16x16_bf16 v[72:75], v[48:49], v[68:69], v[72:75]
    s_waitcnt lgkmcnt(6)
    v_mfma_f32_16x16x16_bf16 v[76:79], v[50:51], v[68:69], v[76:79]
    s_waitcnt lgkmcnt(5)
    v_mfma_f32_16x16x16_bf16 v[80:83], v[52:53], v[68:69], v[80:83]
    s_waitcnt lgkmcnt(4)
    v_mfma_f32_16x16x16_bf16 v[84:87], v[54:55], v[68:69], v[84:87]
    s_waitcnt lgkmcnt(3)
    v_mfma_f32_16x16x16_bf16 v[88:91], v[56:57], v[68:69], v[88:91]
    s_waitcnt lgkmcnt(2)
    v_mfma_f32_16x16x16_bf16 v[92:95], v[58:59], v[68:69], v[92:95]
    s_waitcnt lgkmcnt(1)
    v_mfma_f32_16x16x16_bf16 v[96:99], v[60:61], v[68:69], v[96:99]
    s_waitcnt lgkmcnt(0)
    ds_write_b32 v6, v9
    v_mfma_f32_16x16x16_bf16 v[100:103], v[62:63], v[68:69], v[100:103]
    s_add_u32 s27, s27, 3
    s_sub_u32 s37, s37, 64
    s_cmp_ge_i32 s27, s52
    s_cbranch_scc1 L_final
    s_lshl_b32 s54, s27, 1
    s_sub_u32 s36, s54, 3
    s_max_i32 s36, s36, s27
    s_add_u32 s36, s36, 1
    s_cmp_ge_i32 s38, s36
    s_cbranch_scc1 L_okk2
L_pollk2:
    ds_read_b32 v7, v5
    s_waitcnt lgkmcnt(0)
    v_readfirstlane_b32 s38, v7
    s_cmp_lt_i32 s38, s36
    s_cbranch_scc1 L_pollk2
L_okk2:
    ds_read_b128 v[32:35], v128 offset:0
    ds_read_b128 v[36:39], v129 offset:0
    ds_read_b128 v[40:43], v130 offset:0
    ds_read_b128 v[44:47], v131 offset:0
    s_waitcnt lgkmcnt(3)
    v_mfma_f32_16x16x32_bf16 v[64:67], v[32:35], v[16:19], 0
    s_waitcnt lgkmcnt(2)
    v_mfma_f32_16x16x32_bf16 v[64:67], v[36:39], v[20:23], v[64:67]
    s_waitcnt lgkmcnt(1)
    v_mfma_f32_16x16x32_bf16 v[64:67], v[40:43], v[24:27], v[64:67]
    s_waitcnt lgkmcnt(0)
    v_mfma_f32_16x16x32_bf16 v[64:67], v[44:47], v[28:31], v[64:67]
    s_add_u32 s36, s54, 5
    s_add_u32 s54, s53, s27
    s_min_i32 s36, s36, s54
    s_nop 4
    v_max_f32 v121, v64, v65
    v_max3_f32 v121, v66, v67, v121
    v_mov_b32 v122, v121
    s_nop 1
    v_permlane16_swap_b32 v121, v122
    v_max_f32 v121, v121, v122
    v_mov_b32 v122, v121
    s_nop 1
    v_permlane32_swap_b32 v121, v122
    v_max3_f32 v118, v121, v122, v116
    v_sub_f32 v123, v116, v118
    v_mul_f32 v119, s26, v118
    v_mul_f32 v123, s26, v123
    v_fma_f32 v124, v64, s26, -v119
    v_fma_f32 v125, v65, s26, -v119
    v_fma_f32 v126, v66, s26, -v119
    v_fma_f32 v127, v67, s26, -v119
    v_exp_f32 v120, v123
    v_exp_f32 v124, v124
    v_exp_f32 v125, v125
    v_exp_f32 v126, v126
    v_exp_f32 v127, v127
    v_mov_b32 v116, v118
    v_mul_f32 v72, v120, v72
    v_mul_f32 v73, v120, v73
    v_mul_f32 v74, v120, v74
    v_mul_f32 v75, v120, v75
    v_mul_f32 v76, v120, v76
    v_mul_f32 v77, v120, v77
    v_mul_f32 v78, v120, v78
    v_mul_f32 v79, v120, v79
    v_mul_f32 v80, v120, v80
    v_mul_f32 v81, v120, v81
    v_mul_f32 v82, v120, v82
    v_mul_f32 v83, v120, v83
    v_mul_f32 v84, v120, v84
    v_mul_f32 v85, v120, v85
    v_mul_f32 v86, v120, v86
    v_mul_f32 v87, v120, v87
    v_mul_f32 v88, v120, v88
    v_mul_f32 v89, v120, v89
    v_mul_f32 v90, v120, v90
    v_mul_f32 v91, v120, v91
    v_mul_f32 v92, v120, v92
    v_mul_f32 v93, v120, v93
    v_mul_f32 v94, v120, v94
    v_mul_f32 v95, v120, v95
    v_mul_f32 v96, v120, v96
    v_mul_f32 v97, v120, v97
    v_mul_f32 v98, v120, v98
    v_mul_f32 v99, v120, v99
    v_mul_f32 v100, v120, v100
    v_mul_f32 v101, v120, v101
    v_mul_f32 v102, v120, v102
    v_mul_f32 v103, v120, v103
    v_add_f32 v121, v124, v125
    v_add_f32 v122, v126, v127
    v_cvt_pk_bf16_f32 v68, v124, v125
    v_cvt_pk_bf16_f32 v69, v126, v127
    v_add_f32 v121, v121, v122
    v_fma_f32 v117, v117, v120, v121
    s_cmp_ge_i32 s38, s36
    s_cbranch_scc1 L_okv2
L_pollv2:
    ds_read_b32 v7, v5
    s_waitcnt lgkmcnt(0)
    v_readfirstlane_b32 s38, v7
    s_cmp_lt_i32 s38, s36
    s_cbranch_scc1 L_pollv2
L_okv2:
    ds_read_b64_tr_b16 v[48:49], v132 offset:0
    ds_read_b64_tr_b16 v[50:51], v133 offset:0
    ds_read_b64_tr_b16 v[52:53], v134 offset:0
    ds_read_b64_tr_b16 v[54:55], v135 offset:0
    ds_read_b64_tr_b16 v[56:57], v136 offset:0
    ds_read_b64_tr_b16 v[58:59], v137 offset:0
    ds_read_b64_tr_b16 v[60:61], v138 offset:0
    ds_read_b64_tr_b16 v[62:63], v139 offset:0
    s_add_u32 s27, s27, 1
    v_mov_b32 v9, s27
    s_waitcnt lgkmcnt(7)
    v_mfma_f32_16x16x16_bf16 v[72:75], v[48:49], v[68:69], v[72:75]
    s_waitcnt lgkmcnt(6)
    v_mfma_f32_16x16x16_bf16 v[76:79], v[50:51], v[68:69], v[76:79]
    s_waitcnt lgkmcnt(5)
    v_mfma_f32_16x16x16_bf16 v[80:83], v[52:53], v[68:69], v[80:83]
    s_waitcnt lgkmcnt(4)
    v_mfma_f32_16x16x16_bf16 v[84:87], v[54:55], v[68:69], v[84:87]
    s_waitcnt lgkmcnt(3)
    v_mfma_f32_16x16x16_bf16 v[88:91], v[56:57], v[68:69], v[88:91]
    s_waitcnt lgkmcnt(2)
    v_mfma_f32_16x16x16_bf16 v[92:95], v[58:59], v[68:69], v[92:95]
    s_waitcnt lgkmcnt(1)
    v_mfma_f32_16x16x16_bf16 v[96:99], v[60:61], v[68:69], v[96:99]
    s_waitcnt lgkmcnt(0)
    ds_write_b32 v6, v9
    v_mfma_f32_16x16x16_bf16 v[100:103], v[62:63], v[68:69], v[100:103]
    s_add_u32 s27, s27, 3
    s_sub_u32 s37, s37, 64
    s_cmp_ge_i32 s27, s52
    s_cbranch_scc1 L_final
    s_lshl_b32 s54, s27, 1
    s_sub_u32 s36, s54, 3
    s_max_i32 s36, s36, s27
    s_add_u32 s36, s36, 1
    s_cmp_ge_i32 s38, s36
    s_cbranch_scc1 L_okk3
L_pollk3:
    ds_read_b32 v7, v5
    s_waitcnt lgkmcnt(0)
    v_readfirstlane_b32 s38, v7
    s_cmp_lt_i32 s38, s36
    s_cbranch_scc1 L_pollk3
L_okk3:
    ds_read_b128 v[32:35], v128 offset:32768
    ds_read_b128 v[36:39], v129 offset:32768
    ds_read_b128 v[40:43], v130 offset:32768
    ds_read_b128 v[44:47], v131 offset:32768
    s_waitcnt lgkmcnt(3)
    v_mfma_f32_16x16x32_bf16 v[64:67], v[32:35], v[16:19], 0
    s_waitcnt lgkmcnt(2)
    v_mfma_f32_16x16x32_bf16 v[64:67], v[36:39], v[20:23], v[64:67]
    s_waitcnt lgkmcnt(1)
    v_mfma_f32_16x16x32_bf16 v[64:67], v[40:43], v[24:27], v[64:67]
    s_waitcnt lgkmcnt(0)
    v_mfma_f32_16x16x32_bf16 v[64:67], v[44:47], v[28:31], v[64:67]
    s_add_u32 s36, s54, 5
    s_add_u32 s54, s53, s27
    s_min_i32 s36, s36, s54
    s_nop 4
    v_max_f32 v121, v64, v65
    v_max3_f32 v121, v66, v67, v121
    v_mov_b32 v122, v121
    s_nop 1
    v_permlane16_swap_b32 v121, v122
    v_max_f32 v121, v121, v122
    v_mov_b32 v122, v121
    s_nop 1
    v_permlane32_swap_b32 v121, v122
    v_max3_f32 v118, v121, v122, v116
    v_sub_f32 v123, v116, v118
    v_mul_f32 v119, s26, v118
    v_mul_f32 v123, s26, v123
    v_fma_f32 v124, v64, s26, -v119
    v_fma_f32 v125, v65, s26, -v119
    v_fma_f32 v126, v66, s26, -v119
    v_fma_f32 v127, v67, s26, -v119
    v_exp_f32 v120, v123
    v_exp_f32 v124, v124
    v_exp_f32 v125, v125
    v_exp_f32 v126, v126
    v_exp_f32 v127, v127
    v_mov_b32 v116, v118
    v_mul_f32 v72, v120, v72
    v_mul_f32 v73, v120, v73
    v_mul_f32 v74, v120, v74
    v_mul_f32 v75, v120, v75
    v_mul_f32 v76, v120, v76
    v_mul_f32 v77, v120, v77
    v_mul_f32 v78, v120, v78
    v_mul_f32 v79, v120, v79
    v_mul_f32 v80, v120, v80
    v_mul_f32 v81, v120, v81
    v_mul_f32 v82, v120, v82
    v_mul_f32 v83, v120, v83
    v_mul_f32 v84, v120, v84
    v_mul_f32 v85, v120, v85
    v_mul_f32 v86, v120, v86
    v_mul_f32 v87, v120, v87
    v_mul_f32 v88, v120, v88
    v_mul_f32 v89, v120, v89
    v_mul_f32 v90, v120, v90
    v_mul_f32 v91, v120, v91
    v_mul_f32 v92, v120, v92
    v_mul_f32 v93, v120, v93
    v_mul_f32 v94, v120, v94
    v_mul_f32 v95, v120, v95
    v_mul_f32 v96, v120, v96
    v_mul_f32 v97, v120, v97
    v_mul_f32 v98, v120, v98
    v_mul_f32 v99, v120, v99
    v_mul_f32 v100, v120, v100
    v_mul_f32 v101, v120, v101
    v_mul_f32 v102, v120, v102
    v_mul_f32 v103, v120, v103
    v_add_f32 v121, v124, v125
    v_add_f32 v122, v126, v127
    v_cvt_pk_bf16_f32 v68, v124, v125
    v_cvt_pk_bf16_f32 v69, v126, v127
    v_add_f32 v121, v121, v122
    v_fma_f32 v117, v117, v120, v121
    s_cmp_ge_i32 s38, s36
    s_cbranch_scc1 L_okv3
L_pollv3:
    ds_read_b32 v7, v5
    s_waitcnt lgkmcnt(0)
    v_readfirstlane_b32 s38, v7
    s_cmp_lt_i32 s38, s36
    s_cbranch_scc1 L_pollv3
L_okv3:
    ds_read_b64_tr_b16 v[48:49], v132 offset:32768
    ds_read_b64_tr_b16 v[50:51], v133 offset:32768
    ds_read_b64_tr_b16 v[52:53], v134 offset:32768
    ds_read_b64_tr_b16 v[54:55], v135 offset:32768
    ds_read_b64_tr_b16 v[56:57], v136 offset:32768
    ds_read_b64_tr_b16 v[58:59], v137 offset:32768
    ds_read_b64_tr_b16 v[60:61], v138 offset:32768
    ds_read_b64_tr_b16 v[62:63], v139 offset:32768
    s_add_u32 s27, s27, 1
    v_mov_b32 v9, s27
    s_waitcnt lgkmcnt(7)
    v_mfma_f32_16x16x16_bf16 v[72:75], v[48:49], v[68:69], v[72:75]
    s_waitcnt lgkmcnt(6)
    v_mfma_f32_16x16x16_bf16 v[76:79], v[50:51], v[68:69], v[76:79]
    s_waitcnt lgkmcnt(5)
    v_mfma_f32_16x16x16_bf16 v[80:83], v[52:53], v[68:69], v[80:83]
    s_waitcnt lgkmcnt(4)
    v_mfma_f32_16x16x16_bf16 v[84:87], v[54:55], v[68:69], v[84:87]
    s_waitcnt lgkmcnt(3)
    v_mfma_f32_16x16x16_bf16 v[88:91], v[56:57], v[68:69], v[88:91]
    s_waitcnt lgkmcnt(2)
    v_mfma_f32_16x16x16_bf16 v[92:95], v[58:59], v[68:69], v[92:95]
    s_waitcnt lgkmcnt(1)
    v_mfma_f32_16x16x16_bf16 v[96:99], v[60:61], v[68:69], v[96:99]
    s_waitcnt lgkmcnt(0)
    ds_write_b32 v6, v9
    v_mfma_f32_16x16x16_bf16 v[100:103], v[62:63], v[68:69], v[100:103]
    s_add_u32 s27, s27, 3
    s_sub_u32 s37, s37, 64
    s_branch L_cloop
L_final:
    s_bfe_u32 s40, s27, 0x20002
    s_lshl_b32 s40, s40, 15
    v_add_u32 v104, s40, v104
    v_add_u32 v105, s40, v105
    v_add_u32 v106, s40, v106
    v_add_u32 v107, s40, v107
    v_add_u32 v108, s40, v108
    v_add_u32 v109, s40, v109
    v_add_u32 v110, s40, v110
    v_add_u32 v111, s40, v111
    v_add_u32 v112, s40, v112
    v_add_u32 v113, s40, v113
    v_add_u32 v114, s40, v114
    v_add_u32 v115, s40, v115
    s_cmp_lg_u32 s70, 1
    s_cbranch_scc1 L_fin1
    v_mov_b32 v121, 132900
L_fdec:
    ds_read_b32 v7, v121
    s_waitcnt lgkmcnt(0)
    v_readfirstlane_b32 s40, v7
    s_cmp_eq_u32 s40, 0
    s_cbranch_scc1 L_fdec
    s_cmp_eq_u32 s40, 2
    s_cbranch_scc1 L_fin1
    v_lshrrev_b32 v121, 1, v14
    buffer_load_dwordx4 v[140:143], v14, s[64:67], s68 offen sc1
    s_add_u32 s40, s68, 4096
    buffer_load_dwordx4 v[144:147], v14, s[64:67], s40 offen sc1
    s_add_u32 s40, s68, 8192
    buffer_load_dwordx2 v[148:149], v121, s[64:67], s40 offen sc1
    s_mov_b32 s70, 3
L_fin1:
    s_lshl_b32 s54, s27, 1
    s_sub_u32 s36, s54, 3
    s_max_i32 s36, s36, s27
    s_add_u32 s36, s36, 1
    s_cmp_ge_i32 s38, s36
    s_cbranch_scc1 L_okkf
L_pollkf:
    ds_read_b32 v7, v5
    s_waitcnt lgkmcnt(0)
    v_readfirstlane_b32 s38, v7
    s_cmp_lt_i32 s38, s36
    s_cbranch_scc1 L_pollkf
L_okkf:
    ds_read_b128 v[32:35], v104 offset:0
    ds_read_b128 v[36:39], v105 offset:0
    ds_read_b128 v[40:43], v106 offset:0
    ds_read_b128 v[44:47], v107 offset:0
    s_waitcnt lgkmcnt(3)
    v_mfma_f32_16x16x32_bf16 v[64:67], v[32:35], v[16:19], 0
    s_waitcnt lgkmcnt(2)
    v_mfma_f32_16x16x32_bf16 v[64:67], v[36:39], v[20:23], v[64:67]
    s_waitcnt lgkmcnt(1)
    v_mfma_f32_16x16x32_bf16 v[64:67], v[40:43], v[24:27], v[64:67]
    s_waitcnt lgkmcnt(0)
    v_mfma_f32_16x16x32_bf16 v[64:67], v[44:47], v[28:31], v[64:67]
    s_add_u32 s36, s54, 5
    s_add_u32 s54, s53, s27
    s_min_i32 s36, s36, s54
    s_sub_u32 s40, s37, 0
    v_cmp_gt_i32 s[42:43], s40, v8
    s_sub_u32 s40, s37, 1
    v_cmp_gt_i32 s[44:45], s40, v8
    s_sub_u32 s40, s37, 2
    v_cmp_gt_i32 s[46:47], s40, v8
    s_sub_u32 s40, s37, 3
    v_cmp_gt_i32 s[48:49], s40, v8
    v_mov_b32 v121, s39
    v_cndmask_b32 v64, v121, v64, s[42:43]
    v_cndmask_b32 v65, v121, v65, s[44:45]
    v_cndmask_b32 v66, v121, v66, s[46:47]
    v_cndmask_b32 v67, v121, v67, s[48:49]
    v_max_f32 v121, v64, v65
    v_max3_f32 v121, v66, v67, v121
    v_mov_b32 v122, v121
    s_nop 1
    v_permlane16_swap_b32 v121, v122
    v_max_f32 v121, v121, v122
    v_mov_b32 v122, v121
    s_nop 1
    v_permlane32_swap_b32 v121, v122
    v_max3_f32 v118, v121, v122, v116
    v_sub_f32 v123, v116, v118
    v_mul_f32 v119, s26, v118
    v_mul_f32 v123, s26, v123
    v_fma_f32 v124, v64, s26, -v119
    v_fma_f32 v125, v65, s26, -v119
    v_fma_f32 v126, v66, s26, -v119
    v_fma_f32 v127, v67, s26, -v119
    v_exp_f32 v120, v123
    v_exp_f32 v124, v124
    v_exp_f32 v125, v125
    v_exp_f32 v126, v126
    v_exp_f32 v127, v127
    v_mov_b32 v116, v118
    v_mul_f32 v72, v120, v72
    v_mul_f32 v73, v120, v73
    v_mul_f32 v74, v120, v74
    v_mul_f32 v75, v120, v75
    v_mul_f32 v76, v120, v76
    v_mul_f32 v77, v120, v77
    v_mul_f32 v78, v120, v78
    v_mul_f32 v79, v120, v79
    v_mul_f32 v80, v120, v80
    v_mul_f32 v81, v120, v81
    v_mul_f32 v82, v120, v82
    v_mul_f32 v83, v120, v83
    v_mul_f32 v84, v120, v84
    v_mul_f32 v85, v120, v85
    v_mul_f32 v86, v120, v86
    v_mul_f32 v87, v120, v87
    v_mul_f32 v88, v120, v88
    v_mul_f32 v89, v120, v89
    v_mul_f32 v90, v120, v90
    v_mul_f32 v91, v120, v91
    v_mul_f32 v92, v120, v92
    v_mul_f32 v93, v120, v93
    v_mul_f32 v94, v120, v94
    v_mul_f32 v95, v120, v95
    v_mul_f32 v96, v120, v96
    v_mul_f32 v97, v120, v97
    v_mul_f32 v98, v120, v98
    v_mul_f32 v99, v120, v99
    v_mul_f32 v100, v120, v100
    v_mul_f32 v101, v120, v101
    v_mul_f32 v102, v120, v102
    v_mul_f32 v103, v120, v103
    v_add_f32 v121, v124, v125
    v_add_f32 v122, v126, v127
    v_cvt_pk_bf16_f32 v68, v124, v125
    v_cvt_pk_bf16_f32 v69, v126, v127
    v_add_f32 v121, v121, v122
    v_fma_f32 v117, v117, v120, v121
L_noblock:
    v_mov_b32 v122, v117
    s_nop 1
    v_permlane16_swap_b32 v117, v122
    v_add_f32 v117, v117, v122
    v_mov_b32 v122, v117
    ds_write_b32 v10, v116
    s_nop 0
    v_permlane32_swap_b32 v117, v122
    v_add_f32 v117, v117, v122
    ds_write_b32 v10, v117 offset:256
    s_waitcnt lgkmcnt(0)
    s_barrier
    ds_read_b128 v[16:19], v11
    ds_read_b128 v[20:23], v11 offset:256
    s_waitcnt lgkmcnt(1)
    v_max_f32 v24, v16, v17
    v_max3_f32 v24, v18, v19, v24
    v_mul_f32 v24, s26, v24
    v_fma_f32 v16, v16, s26, -v24
    v_fma_f32 v17, v17, s26, -v24
    v_fma_f32 v18, v18, s26, -v24
    v_fma_f32 v19, v19, s26, -v24
    v_exp_f32 v16, v16
    v_exp_f32 v17, v17
    v_exp_f32 v18, v18
    v_exp_f32 v19, v19
    s_waitcnt lgkmcnt(0)
    v_mul_f32 v25, v16, v20
    v_fmac_f32 v25, v17, v21
    v_fmac_f32 v25, v18, v22
    v_fmac_f32 v25, v19, v23
    s_cmp_lg_u32 s70, 0
    s_cbranch_scc1 L_nonorm
    v_rcp_f32 v26, v25
    s_nop 0
    v_mul_f32 v16, v16, v26
    v_mul_f32 v17, v17, v26
    v_mul_f32 v18, v18, v26
    v_mul_f32 v19, v19, v26
L_nonorm:
    s_cmp_ge_u32 s27, s25
    s_cbranch_scc1 L_fzero
    s_cmp_ge_i32 s38, s36
    s_cbranch_scc1 L_okvf
L_pollvf:
    ds_read_b32 v7, v5
    s_waitcnt lgkmcnt(0)
    v_readfirstlane_b32 s38, v7
    s_cmp_lt_i32 s38, s36
    s_cbranch_scc1 L_pollvf
L_okvf:
    ds_read_b64_tr_b16 v[48:49], v108
    ds_read_b64_tr_b16 v[50:51], v109
    ds_read_b64_tr_b16 v[52:53], v110
    ds_read_b64_tr_b16 v[54:55], v111
    ds_read_b64_tr_b16 v[56:57], v112
    ds_read_b64_tr_b16 v[58:59], v113
    ds_read_b64_tr_b16 v[60:61], v114
    ds_read_b64_tr_b16 v[62:63], v115
    s_waitcnt lgkmcnt(7)
    v_mfma_f32_16x16x16_bf16 v[72:75], v[48:49], v[68:69], v[72:75]
    s_waitcnt lgkmcnt(6)
    v_mfma_f32_16x16x16_bf16 v[76:79], v[50:51], v[68:69], v[76:79]
    s_waitcnt lgkmcnt(5)
    v_mfma_f32_16x16x16_bf16 v[80:83], v[52:53], v[68:69], v[80:83]
    s_waitcnt lgkmcnt(4)
    v_mfma_f32_16x16x16_bf16 v[84:87], v[54:55], v[68:69], v[84:87]
    s_waitcnt lgkmcnt(3)
    v_mfma_f32_16x16x16_bf16 v[88:91], v[56:57], v[68:69], v[88:91]
    ds_write_b128 v12, v[72:75] offset:0
    s_waitcnt lgkmcnt(3)
    v_mfma_f32_16x16x16_bf16 v[92:95], v[58:59], v[68:69], v[92:95]
    ds_write_b128 v12, v[76:79] offset:1024
    s_waitcnt lgkmcnt(3)
    v_mfma_f32_16x16x16_bf16 v[96:99], v[60:61], v[68:69], v[96:99]
    ds_write_b128 v12, v[80:83] offset:2048
    s_waitcnt lgkmcnt(3)
    v_mfma_f32_16x16x16_bf16 v[100:103], v[62:63], v[68:69], v[100:103]
    ds_write_b128 v12, v[84:87] offset:3072
    ds_write_b128 v12, v[88:91] offset:4096
    ds_write_b128 v12, v[92:95] offset:5120
    s_nop 1
    ds_write_b128 v12, v[96:99] offset:6144
    s_nop 1
    ds_write_b128 v12, v[100:103] offset:7168
    s_branch L_fxe
L_fzero:
    ds_write_b128 v12, v[72:75] offset:0
    ds_write_b128 v12, v[76:79] offset:1024
    ds_write_b128 v12, v[80:83] offset:2048
    ds_write_b128 v12, v[84:87] offset:3072
    ds_write_b128 v12, v[88:91] offset:4096
    ds_write_b128 v12, v[92:95] offset:5120
    ds_write_b128 v12, v[96:99] offset:6144
    ds_write_b128 v12, v[100:103] offset:7168
L_fxe:
    s_waitcnt lgkmcnt(0)
    s_barrier
    ds_read_b128 v[32:35], v13 offset:0
    ds_read_b128 v[36:39], v13 offset:256
    ds_read_b128 v[40:43], v13 offset:8192
    ds_read_b128 v[44:47], v13 offset:8448
    ds_read_b128 v[48:51], v13 offset:16384
    ds_read_b128 v[52:55], v13 offset:16640
    ds_read_b128 v[56:59], v13 offset:24576
    ds_read_b128 v[60:63], v13 offset:24832
    s_waitcnt lgkmcnt(7)
    v_mul_f32 v64, v16, v32
    v_mul_f32 v65, v16, v33
    v_mul_f32 v66, v16, v34
    v_mul_f32 v67, v16, v35
    s_waitcnt lgkmcnt(6)
    v_mul_f32 v68, v16, v36
    v_mul_f32 v69, v16, v37
    v_mul_f32 v70, v16, v38
    v_mul_f32 v71, v16, v39
    s_waitcnt lgkmcnt(5)
    v_fmac_f32 v64, v17, v40
    v_fmac_f32 v65, v17, v41
    v_fmac_f32 v66, v17, v42
    v_fmac_f32 v67, v17, v43
    s_waitcnt lgkmcnt(4)
    v_fmac_f32 v68, v17, v44
    v_fmac_f32 v69, v17, v45
    v_fmac_f32 v70, v17, v46
    v_fmac_f32 v71, v17, v47
    s_waitcnt lgkmcnt(3)
    v_fmac_f32 v64, v18, v48
    v_fmac_f32 v65, v18, v49
    v_fmac_f32 v66, v18, v50
    v_fmac_f32 v67, v18, v51
    s_waitcnt lgkmcnt(2)
    v_fmac_f32 v68, v18, v52
    v_fmac_f32 v69, v18, v53
    v_fmac_f32 v70, v18, v54
    v_fmac_f32 v71, v18, v55
    s_waitcnt lgkmcnt(1)
    v_fmac_f32 v64, v19, v56
    v_fmac_f32 v65, v19, v57
    v_fmac_f32 v66, v19, v58
    v_fmac_f32 v67, v19, v59
    s_waitcnt lgkmcnt(0)
    v_fmac_f32 v68, v19, v60
    v_fmac_f32 v69, v19, v61
    v_fmac_f32 v70, v19, v62
    v_fmac_f32 v71, v19, v63
    s_cmp_lg_u32 s70, 0
    s_cbranch_scc1 L_special
L_store:
    v_cvt_pk_bf16_f32 v72, v64, v65
    v_cvt_pk_bf16_f32 v73, v66, v67
    v_cvt_pk_bf16_f32 v74, v68, v69
    v_cvt_pk_bf16_f32 v75, v70, v71
    buffer_store_dwordx4 v[72:75], v15, s[32:35], s69 offen
    s_endpgm
L_job2:
    s_mov_b32 s14, 1
    s_mov_b32 s24, s56
    s_mov_b32 s23, s57
    s_mov_b32 s26, s58
    v_mov_b32 v9, 0
    ds_write_b32 v6, v9
    s_waitcnt lgkmcnt(0)
    s_barrier
    s_branch L_cjob
L_special:
    s_cmp_eq_u32 s70, 3
    s_cbranch_scc1 L_combine
    s_cmp_eq_u32 s70, 2
    s_cbranch_scc1 L_publish
    v_mov_b32 v140, v64
    v_mov_b32 v141, v65
    v_mov_b32 v142, v66
    v_mov_b32 v143, v67
    v_mov_b32 v144, v68
    v_mov_b32 v145, v69
    v_mov_b32 v146, v70
    v_mov_b32 v147, v71
    v_mov_b32 v148, v24
    v_mov_b32 v149, v25
    s_mov_b32 s70, 3
    s_branch L_job2
L_publish:
    v_lshrrev_b32 v121, 1, v14
    buffer_store_dwordx4 v[64:67], v14, s[64:67], s68 offen sc1
    s_add_u32 s40, s68, 4096
    buffer_store_dwordx4 v[68:71], v14, s[64:67], s40 offen sc1
    s_add_u32 s40, s68, 8192
    buffer_store_dwordx2 v[24:25], v121, s[64:67], s40 offen sc1
    s_mov_b32 s60, s76
    s_mov_b32 s61, s77
    s_movk_i32 s62, 0x100
    s_mov_b32 s63, 0x20000
    v_mov_b32 v26, s59
    v_mov_b32 v27, 1
    s_mov_b32 s24, s12
    s_lshl_b32 s23, s2, 12
    s_mov_b32 s26, s13
    s_mov_b32 s70, 0
    v_mov_b32 v9, 0
    ds_write_b32 v6, v9
    s_waitcnt vmcnt(0) lgkmcnt(0)
    s_barrier
    s_cmp_lg_u32 s16, 0
    s_cbranch_scc1 L_cjob
    s_mov_b64 exec, 1
    buffer_store_byte v27, v26, s[60:63], 0 offen sc1
    s_mov_b64 exec, -1
    s_branch L_cjob
L_combine:
    s_waitcnt vmcnt(0)
    v_max_f32 v26, v24, v148
    v_sub_f32 v24, v24, v26
    v_sub_f32 v27, v148, v26
    v_exp_f32 v24, v24
    v_exp_f32 v27, v27
    s_nop 0
    v_mul_f32 v25, v24, v25
    v_mul_f32 v26, v27, v149
    v_add_f32 v25, v25, v26
    v_rcp_f32 v25, v25
    s_nop 0
    v_mul_f32 v24, v24, v25
    v_mul_f32 v27, v27, v25
    v_mul_f32 v64, v24, v64
    v_mul_f32 v140, v27, v140
    v_mul_f32 v65, v24, v65
    v_mul_f32 v141, v27, v141
    v_mul_f32 v66, v24, v66
    v_mul_f32 v142, v27, v142
    v_mul_f32 v67, v24, v67
    v_mul_f32 v143, v27, v143
    v_mul_f32 v68, v24, v68
    v_mul_f32 v144, v27, v144
    v_mul_f32 v69, v24, v69
    v_mul_f32 v145, v27, v145
    v_mul_f32 v70, v24, v70
    v_mul_f32 v146, v27, v146
    v_mul_f32 v71, v24, v71
    v_mul_f32 v147, v27, v147
    v_add_f32 v64, v64, v140
    v_add_f32 v65, v65, v141
    v_add_f32 v66, v66, v142
    v_add_f32 v67, v67, v143
    v_add_f32 v68, v68, v144
    v_add_f32 v69, v69, v145
    v_add_f32 v70, v70, v146
    v_add_f32 v71, v71, v147
    s_branch L_store
L_end:
    s_endpgm
.section .rodata,"a"
.p2align 6
.amdhsa_kernel standalone__paged_block_table_kv_pagedattention__sampling_kernel
  .amdhsa_next_free_vgpr 152
  .amdhsa_next_free_sgpr 96
  .amdhsa_accum_offset 152
  .amdhsa_group_segment_fixed_size 0
  .amdhsa_kernarg_size 64
  .amdhsa_user_sgpr_count 2
  .amdhsa_user_sgpr_kernarg_segment_ptr 1
  .amdhsa_system_sgpr_workgroup_id_x 1
.end_amdhsa_kernel
```
